```python
import torch

def _softmax(x, axis=-1):
    return torch.softmax(x, dim=axis)
def _gelu(x):
    return torch.nn.functional.gelu(x, approximate="tanh")
def _silu(x):
    return torch.nn.functional.silu(x)
def _sigmoid(x):
    return torch.sigmoid(x)
def _layernorm(x, axis=-1, eps=1e-5):
    m = x.mean(dim=axis, keepdim=True)
    v = x.var(dim=axis, keepdim=True, unbiased=False)
    return (x - m) / torch.sqrt(v + eps)
def _scatter_add(tgt, idx, src, axis=0):
    return tgt.clone().index_add_(axis, idx, src)
def _segment_sum(src, seg, n):
    out = torch.zeros((n,) + src.shape[1:], dtype=src.dtype)
    return out.index_add_(0, seg, src)
def _pad(x, pw):
    flat = tuple(v for pair in reversed(pw) for v in pair)
    return torch.nn.functional.pad(x, flat)

kernel_name = 'concat_heads__ssm_conv_s4d__spectral_gfnet__prompt'

def setup_inputs():

    _w = (lambda a: (lambda t: t.to(torch.bfloat16) if t.is_floating_point() else t)(torch.as_tensor(a)))
    def _A_setup():
        Bsz, L, D, N = 1, 2048, 1024, 128
        return {
            "u": _w((lambda *s: torch.randn(*s, dtype=torch.bfloat16) * 0.05)(Bsz, L, D)),
            "log_A_real": _w((lambda *s: torch.randn(*s, dtype=torch.bfloat16) * 6.4)(D, N) * 0.5),
            "A_imag": _w((lambda *s: torch.randn(*s, dtype=torch.bfloat16) * 0.05)(D, N) * 3.14),
            "C_real": _w((lambda *s: torch.randn(*s, dtype=torch.bfloat16) * 0.05)(D, N) / N ** 0.5),
            "C_imag": _w((lambda *s: torch.randn(*s, dtype=torch.bfloat16) * 0.05)(D, N) / N ** 0.5),
            "log_dt": _w((lambda *s: torch.randn(*s, dtype=torch.bfloat16) * 0.05)(D) * 0.5 - 4.0),
            "D_skip": _w((lambda *s: torch.randn(*s, dtype=torch.bfloat16) * 0.05)(D)),
        }
    _A_in = _A_setup()

    def _B_setup():
        B, S, D = 1, 2048, 1024
        Df = D // 2 + 1
        return {
            "x": _w((lambda *s: torch.randn(*s, dtype=torch.bfloat16) * 0.05)(B, S, D)),
            "w_r": _w((lambda *s: torch.randn(*s, dtype=torch.bfloat16) * 0.8)(S, Df) * 0.02),
            "w_i": _w((lambda *s: torch.randn(*s, dtype=torch.bfloat16) * 0.8)(S, Df) * 0.02),
        }
    _B_in = _B_setup()

    return {
        "A_u": _A_in["u"],
        "A_log_A_real": _A_in["log_A_real"],
        "A_A_imag": _A_in["A_imag"],
        "A_C_real": _A_in["C_real"],
        "A_C_imag": _A_in["C_imag"],
        "A_log_dt": _A_in["log_dt"],
        "A_D_skip": _A_in["D_skip"],
        "B_x": _B_in["x"],
        "B_w_r": _B_in["w_r"],
        "B_w_i": _B_in["w_i"],
    }

def reference(A_u, A_log_A_real, A_A_imag, A_C_real, A_C_imag, A_log_dt, A_D_skip, B_x, B_w_r, B_w_i):
    def _A_ref(u, log_A_real, A_imag, C_real, C_imag, log_dt, D_skip):
        L = u.shape[1]
        dt = torch.exp(log_dt)
        A = -torch.exp(log_A_real) + 1j * A_imag
        C = (C_real + 1j * C_imag) * dt[:, None]
        pos = (lambda x, dt: x.to(dt))(torch.arange(L), log_dt.dtype)
        P = torch.exp((A * dt[:, None])[:, :, None] * pos[None, None, :])
        K = 2.0 * torch.einsum("dn,dnl->dl", C, P).real
        L2 = 2 * L
        u_t = (lambda x, *d: x.permute(*d))(u, 0, 2, 1)
        Kf = (lambda x, *a, **k: torch.fft.rfft(x.float(), *a, **k))(K, L2)
        Uf = (lambda x, *a, **k: torch.fft.rfft(x.float(), *a, **k))(u_t, L2)
        y = (lambda x, *a, **k: torch.fft.irfft(x, *a, **k).to(torch.bfloat16))(Uf * Kf[None, :, :], L2)[:, :, :L]
        y = (lambda x, *d: x.permute(*d))(y, 0, 2, 1)
        return y + u * D_skip[None, None, :]

    def _B_ref(x, w_r, w_i):
        B, S, D = x.shape
        X = (lambda x, axes=(-2,-1): torch.fft.rfft2(x.float(), dim=axes))(x, axes=(-2, -1))
        W = w_r + 1j * w_i
        X = X * W
        y = (lambda x, s, axes=(-2,-1): torch.fft.irfft2(x, s=s, dim=axes).to(torch.bfloat16))(X, (S, D), axes=(-2, -1))
        return y

    a = _A_ref(A_u, A_log_A_real, A_A_imag, A_C_real, A_C_imag, A_log_dt, A_D_skip)
    b = _B_ref(B_x, B_w_r, B_w_i)
    return torch.concatenate([a, b], axis=-1)
```

```asm
; @launch grid=(256,1,1) block=(768,1,1) lds=161664
.amdgcn_target "amdgcn-amd-amdhsa--gfx950"
.text
.globl concat_heads__ssm_conv_s4d__spectral_gfnet__prompt_kernel
.type concat_heads__ssm_conv_s4d__spectral_gfnet__prompt_kernel,@function
.p2align 8
concat_heads__ssm_conv_s4d__spectral_gfnet__prompt_kernel:
    s_cmp_ge_u32 s2, 256
    s_cbranch_scc1 .exit
    s_load_dwordx16 s[16:31], s[0:1], 0
    s_load_dwordx8 s[32:39], s[0:1], 64
    s_load_dwordx2 s[40:41], s[0:1], 96
    v_lshrrev_b32 v1, 6, v0
    v_and_b32 v2, 63, v0
    v_readfirstlane_b32 s3, v1
    s_nop 1
    s_cmp_ge_u32 s3, 8
    s_cbranch_scc1 .role_a
    s_cmp_eq_u32 s3, 7
    s_cbranch_scc1 .role_m
    s_cmp_ge_u32 s3, 5
    s_cbranch_scc1 .role_t
    s_setprio 2
    s_mov_b32 s8, s3
    s_and_b32 s15, s3, 3
    s_sub_u32 s9, 8, s8
    s_lshl_b32 s4, s2, 11
    v_lshlrev_b32 v3, 3, v0
    v_add_u32 v7, s4, v3
    s_cmp_eq_u32 s3, 4
    s_cbranch_scc0 .b1_nopf
    s_getpc_b64 s[6:7]
.pc_1:
    s_sub_u32 s6, s6, .pc_1-concat_heads__ssm_conv_s4d__spectral_gfnet__prompt_kernel
    s_subb_u32 s7, s7, 0
    v_lshlrev_b32 v158, 7, v2
    s_lshr_b32 s5, s2, 3
    s_and_b32 s5, s5, 3
    s_mul_i32 s5, s5, 8192
    v_add_u32 v158, s5, v158
    v_min_u32 v156, .exit-concat_heads__ssm_conv_s4d__spectral_gfnet__prompt_kernel, v158
    v_mov_b32 v157, s7
    v_add_co_u32 v156, vcc, s6, v156
    s_nop 1
    v_addc_co_u32 v157, vcc, 0, v157, vcc
    global_load_dword v159, v[156:157], off
.b1_nopf:
    v_and_b32 v64, 31, v2
    v_cvt_f32_u32 v64, v64
    v_mul_f32 v64, 0x3d000000, v64
    v_lshrrev_b32 v65, 5, v2
    v_cvt_f32_u32 v65, v65
    v_mul_f32 v65, 4.0, v65
    v_mul_f32 v65, v65, v64
    v_mul_f32 v71, 0x40a00000, v64
    v_and_b32 v72, 16, v2
    v_lshlrev_b32 v72, 11, v72
    v_lshl_or_b32 v72, v72, 16, v72
    v_cos_f32 v67, v65
    v_sin_f32 v69, v65
    v_mul_f32 v66, 0x3d000000, v65
    v_cos_f32 v120, v66
    v_sin_f32 v136, v66
    v_add_f32 v65, v65, v64
    v_cos_f32 v68, v65
    v_sin_f32 v70, v65
    v_mul_f32 v66, 0x3d000000, v65
    v_cos_f32 v121, v66
    v_sin_f32 v137, v66
    v_add_f32 v65, v65, v64
    v_cvt_pk_bf16_f32 v80, v67, v68
    v_cvt_pk_bf16_f32 v88, v69, v70
    v_cvt_pk_bf16_f32 v96, -v69, -v70
    v_xor_b32 v104, v72, v80
    v_xor_b32 v112, v72, v96
    v_cos_f32 v67, v65
    v_sin_f32 v69, v65
    v_mul_f32 v66, 0x3d000000, v65
    v_cos_f32 v122, v66
    v_sin_f32 v138, v66
    v_add_f32 v65, v65, v64
    v_cos_f32 v68, v65
    v_sin_f32 v70, v65
    v_mul_f32 v66, 0x3d000000, v65
    v_cos_f32 v123, v66
    v_sin_f32 v139, v66
    v_add_f32 v65, v65, v71
    v_cvt_pk_bf16_f32 v81, v67, v68
    v_cvt_pk_bf16_f32 v89, v69, v70
    v_cvt_pk_bf16_f32 v97, -v69, -v70
    v_xor_b32 v105, v72, v81
    v_xor_b32 v113, v72, v97
    v_cos_f32 v67, v65
    v_sin_f32 v69, v65
    v_mul_f32 v66, 0x3d000000, v65
    v_cos_f32 v124, v66
    v_sin_f32 v140, v66
    v_add_f32 v65, v65, v64
    v_cos_f32 v68, v65
    v_sin_f32 v70, v65
    v_mul_f32 v66, 0x3d000000, v65
    v_cos_f32 v125, v66
    v_sin_f32 v141, v66
    v_add_f32 v65, v65, v64
    v_cvt_pk_bf16_f32 v82, v67, v68
    v_cvt_pk_bf16_f32 v90, v69, v70
    v_cvt_pk_bf16_f32 v98, -v69, -v70
    v_xor_b32 v106, v72, v82
    v_xor_b32 v114, v72, v98
    s_waitcnt lgkmcnt(0)
    s_mov_b32 s44, s30
    s_and_b32 s45, s31, 0xffff
    s_mov_b32 s46, 0x400000
    s_mov_b32 s47, 0x00020000
    s_cmp_eq_u32 s3, 4
    s_cbranch_scc1 .b1_noload
    s_mov_b32 s5, 0
    buffer_load_dwordx2 v[16:17], v7, s[44:47], s5 offen
    s_mov_b32 s5, 524288
    buffer_load_dwordx2 v[18:19], v7, s[44:47], s5 offen
    s_mov_b32 s5, 1048576
    buffer_load_dwordx2 v[20:21], v7, s[44:47], s5 offen
    s_mov_b32 s5, 1572864
    buffer_load_dwordx2 v[22:23], v7, s[44:47], s5 offen
    s_mov_b32 s5, 2097152
    buffer_load_dwordx2 v[24:25], v7, s[44:47], s5 offen
    s_mov_b32 s5, 2621440
    buffer_load_dwordx2 v[26:27], v7, s[44:47], s5 offen
    s_mov_b32 s5, 3145728
    buffer_load_dwordx2 v[28:29], v7, s[44:47], s5 offen
    s_mov_b32 s5, 3670016
    buffer_load_dwordx2 v[30:31], v7, s[44:47], s5 offen
.b1_noload:
    s_barrier
    v_and_b32 v32, 15, v2
    v_lshrrev_b32 v33, 4, v2
    v_and_b32 v34, 3, v2
    v_lshrrev_b32 v32, 2, v32
    v_cmp_eq_u32 vcc, v32, v33
    s_nop 1
    v_cndmask_b32 v35, 0, -1, vcc
    s_mov_b32 s4, 0x33221140
    s_mov_b32 s5, 0xa8
    v_add_u32 v41, 0, v34
    v_bfe_u32 v37, s5, v41, 1
    v_lshlrev_b32 v41, 2, v41
    v_bfe_u32 v36, s4, v41, 4
    v_cvt_f32_u32 v36, v36
    v_cvt_f32_u32 v37, v37
    v_mul_f32 v36, 0x3e000000, v36
    v_mul_f32 v38, 0x3e800000, v37
    v_cos_f32 v39, v38
    v_add_f32 v38, v38, v36
    v_cos_f32 v40, v38
    v_add_f32 v38, v38, v36
    v_cvt_pk_bf16_f32 v8, v39, v40
    v_and_b32 v8, v35, v8
    v_cos_f32 v39, v38
    v_add_f32 v38, v38, v36
    v_cos_f32 v40, v38
    v_add_f32 v38, v38, v36
    v_cvt_pk_bf16_f32 v9, v39, v40
    v_and_b32 v9, v35, v9
    v_cos_f32 v39, v38
    v_add_f32 v38, v38, v36
    v_cos_f32 v40, v38
    v_add_f32 v38, v38, v36
    v_cvt_pk_bf16_f32 v10, v39, v40
    v_and_b32 v10, v35, v10
    v_cos_f32 v39, v38
    v_add_f32 v38, v38, v36
    v_cos_f32 v40, v38
    v_add_f32 v38, v38, v36
    v_cvt_pk_bf16_f32 v11, v39, v40
    v_and_b32 v11, v35, v11
    s_mov_b32 s4, 0x33221140
    s_mov_b32 s5, 0xa8
    v_add_u32 v41, 4, v34
    v_bfe_u32 v37, s5, v41, 1
    v_lshlrev_b32 v41, 2, v41
    v_bfe_u32 v36, s4, v41, 4
    v_cvt_f32_u32 v36, v36
    v_cvt_f32_u32 v37, v37
    v_mul_f32 v36, 0x3e000000, v36
    v_mul_f32 v38, 0x3e800000, v37
    v_cos_f32 v39, v38
    v_add_f32 v38, v38, v36
    v_cos_f32 v40, v38
    v_add_f32 v38, v38, v36
    v_cvt_pk_bf16_f32 v12, v39, v40
    v_and_b32 v12, v35, v12
    v_cos_f32 v39, v38
    v_add_f32 v38, v38, v36
    v_cos_f32 v40, v38
    v_add_f32 v38, v38, v36
    v_cvt_pk_bf16_f32 v13, v39, v40
    v_and_b32 v13, v35, v13
    v_cos_f32 v39, v38
    v_add_f32 v38, v38, v36
    v_cos_f32 v40, v38
    v_add_f32 v38, v38, v36
    v_cvt_pk_bf16_f32 v14, v39, v40
    v_and_b32 v14, v35, v14
    v_cos_f32 v39, v38
    v_add_f32 v38, v38, v36
    v_cos_f32 v40, v38
    v_add_f32 v38, v38, v36
    v_cvt_pk_bf16_f32 v15, v39, v40
    v_and_b32 v15, v35, v15
    v_cos_f32 v67, v65
    v_sin_f32 v69, v65
    v_mul_f32 v66, 0x3d000000, v65
    v_cos_f32 v126, v66
    v_sin_f32 v142, v66
    v_add_f32 v65, v65, v64
    v_cos_f32 v68, v65
    v_sin_f32 v70, v65
    v_mul_f32 v66, 0x3d000000, v65
    v_cos_f32 v127, v66
    v_sin_f32 v143, v66
    v_add_f32 v65, v65, v71
    v_cvt_pk_bf16_f32 v83, v67, v68
    v_cvt_pk_bf16_f32 v91, v69, v70
    v_cvt_pk_bf16_f32 v99, -v69, -v70
    v_xor_b32 v107, v72, v83
    v_xor_b32 v115, v72, v99
    v_cos_f32 v67, v65
    v_sin_f32 v69, v65
    v_mul_f32 v66, 0x3d000000, v65
    v_cos_f32 v128, v66
    v_sin_f32 v144, v66
    v_add_f32 v65, v65, v64
    v_cos_f32 v68, v65
    v_sin_f32 v70, v65
    v_mul_f32 v66, 0x3d000000, v65
    v_cos_f32 v129, v66
    v_sin_f32 v145, v66
    v_add_f32 v65, v65, v64
    v_cvt_pk_bf16_f32 v84, v67, v68
    v_cvt_pk_bf16_f32 v92, v69, v70
    v_cvt_pk_bf16_f32 v100, -v69, -v70
    v_xor_b32 v108, v72, v84
    v_xor_b32 v116, v72, v100
    v_cos_f32 v67, v65
    v_sin_f32 v69, v65
    v_mul_f32 v66, 0x3d000000, v65
    v_cos_f32 v130, v66
    v_sin_f32 v146, v66
    v_add_f32 v65, v65, v64
    v_cos_f32 v68, v65
    v_sin_f32 v70, v65
    v_mul_f32 v66, 0x3d000000, v65
    v_cos_f32 v131, v66
    v_sin_f32 v147, v66
    v_add_f32 v65, v65, v71
    v_cvt_pk_bf16_f32 v85, v67, v68
    v_cvt_pk_bf16_f32 v93, v69, v70
    v_cvt_pk_bf16_f32 v101, -v69, -v70
    v_xor_b32 v109, v72, v85
    v_xor_b32 v117, v72, v101
    v_cos_f32 v67, v65
    v_sin_f32 v69, v65
    v_mul_f32 v66, 0x3d000000, v65
    v_cos_f32 v132, v66
    v_sin_f32 v148, v66
    v_add_f32 v65, v65, v64
    v_cos_f32 v68, v65
    v_sin_f32 v70, v65
    v_mul_f32 v66, 0x3d000000, v65
    v_cos_f32 v133, v66
    v_sin_f32 v149, v66
    v_add_f32 v65, v65, v64
    v_cvt_pk_bf16_f32 v86, v67, v68
    v_cvt_pk_bf16_f32 v94, v69, v70
    v_cvt_pk_bf16_f32 v102, -v69, -v70
    v_xor_b32 v110, v72, v86
    v_xor_b32 v118, v72, v102
    v_cos_f32 v67, v65
    v_sin_f32 v69, v65
    v_mul_f32 v66, 0x3d000000, v65
    v_cos_f32 v134, v66
    v_sin_f32 v150, v66
    v_add_f32 v65, v65, v64
    v_cos_f32 v68, v65
    v_sin_f32 v70, v65
    v_mul_f32 v66, 0x3d000000, v65
    v_cos_f32 v135, v66
    v_sin_f32 v151, v66
    v_cvt_pk_bf16_f32 v87, v67, v68
    v_cvt_pk_bf16_f32 v95, v69, v70
    v_cvt_pk_bf16_f32 v103, -v69, -v70
    v_xor_b32 v111, v72, v87
    v_xor_b32 v119, v72, v103
    v_and_b32 v64, 31, v2
    v_lshrrev_b32 v65, 5, v2
    s_lshr_b32 s4, s2, 2
    s_lshl_b32 s5, s2, 14
    v_bfe_u32 v66, v64, 2, 2
    v_add_u32 v66, s4, v66
    v_and_b32 v66, 3, v66
    v_lshlrev_b32 v66, 4, v66
    v_and_b32 v67, 3, v64
    v_lshl_add_u32 v66, v67, 2, v66
    v_lshrrev_b32 v67, 4, v64
    v_lshl_add_u32 v66, v67, 6, v66
    v_lshl_add_u32 v66, v65, 9, v66
    s_lshl_b32 s6, s8, 11
    s_add_u32 s6, s6, s5
    v_add_u32 v164, s6, v66
    v_sub_u32 v64, 31, v64
    v_sub_u32 v65, 1, v65
    v_bfe_u32 v66, v64, 2, 2
    v_add_u32 v66, s4, v66
    v_and_b32 v66, 3, v66
    v_lshlrev_b32 v66, 4, v66
    v_and_b32 v67, 3, v64
    v_lshl_add_u32 v66, v67, 2, v66
    v_lshrrev_b32 v67, 4, v64
    v_lshl_add_u32 v66, v67, 6, v66
    v_lshl_add_u32 v66, v65, 9, v66
    s_lshl_b32 s6, s9, 11
    s_add_u32 s6, s6, s5
    v_add_u32 v165, s6, v66
    v_bfe_u32 v64, v164, 4, 2
    v_and_b32 v65, 4, v164
    v_lshl_or_b32 v65, v64, 3, v65
    v_bfe_u32 v64, v164, 3, 1
    v_or_b32 v166, v64, v65
    v_bfe_u32 v64, v165, 4, 2
    v_and_b32 v65, 4, v165
    v_lshl_or_b32 v65, v64, 3, v65
    v_bfe_u32 v64, v165, 3, 1
    v_or_b32 v167, v64, v65
    v_lshrrev_b32 v64, 5, v2
    v_bfe_u32 v65, v2, 2, 2
    v_lshl_add_u32 v64, v64, 2, v65
    v_lshlrev_b32 v64, 6, v64
    v_bfe_u32 v65, v2, 4, 1
    v_lshl_add_u32 v64, v65, 5, v64
    v_and_b32 v65, 3, v2
    v_lshl_add_u32 v64, v65, 3, v64
    s_lshl_b32 s4, s8, 1
    s_cmp_eq_u32 s8, 4
    s_cselect_b32 s4, 1, s4
    s_lshl_b32 s4, s4, 11
    v_add_u32 v154, s4, v64
    s_cmp_eq_u32 s3, 4
    s_cbranch_scc1 .b1_phaseB
    s_mov_b32 s4, 0x05040100
    s_mov_b32 s5, 0x07060302
    s_waitcnt vmcnt(0)
    v_perm_b32 v32, v18, v16, s4
    v_perm_b32 v33, v22, v20, s4
    v_perm_b32 v34, v26, v24, s4
    v_perm_b32 v35, v30, v28, s4
    s_nop 1
    v_mfma_f32_16x16x32_bf16 v[48:51], v[8:11], v[32:35], 0
    v_mfma_f32_16x16x32_bf16 v[52:55], v[12:15], v[32:35], 0
    v_perm_b32 v36, v18, v16, s5
    v_perm_b32 v37, v22, v20, s5
    v_perm_b32 v38, v26, v24, s5
    v_perm_b32 v39, v30, v28, s5
    s_nop 1
    v_mfma_f32_16x16x32_bf16 v[56:59], v[8:11], v[36:39], 0
    v_mfma_f32_16x16x32_bf16 v[60:63], v[12:15], v[36:39], 0
    v_perm_b32 v40, v19, v17, s4
    v_perm_b32 v41, v23, v21, s4
    v_perm_b32 v42, v27, v25, s4
    v_perm_b32 v43, v31, v29, s4
    s_nop 1
    v_mfma_f32_16x16x32_bf16 v[64:67], v[8:11], v[40:43], 0
    v_mfma_f32_16x16x32_bf16 v[68:71], v[12:15], v[40:43], 0
    v_perm_b32 v44, v19, v17, s5
    v_perm_b32 v45, v23, v21, s5
    v_perm_b32 v46, v27, v25, s5
    v_perm_b32 v47, v31, v29, s5
    s_nop 1
    v_mfma_f32_16x16x32_bf16 v[72:75], v[8:11], v[44:47], 0
    v_mfma_f32_16x16x32_bf16 v[76:79], v[12:15], v[44:47], 0
    v_cvt_pk_bf16_f32 v16, v48, v56
    s_nop 5
    v_cvt_pk_bf16_f32 v17, v64, v72
    ds_write_b64 v3, v[16:17] offset:0
    v_cvt_pk_bf16_f32 v18, v49, v57
    v_cvt_pk_bf16_f32 v19, v65, v73
    ds_write_b64 v3, v[18:19] offset:2048
    v_cvt_pk_bf16_f32 v20, v50, v58
    v_cvt_pk_bf16_f32 v21, v66, v74
    ds_write_b64 v3, v[20:21] offset:4096
    v_cvt_pk_bf16_f32 v22, v51, v59
    v_cvt_pk_bf16_f32 v23, v67, v75
    ds_write_b64 v3, v[22:23] offset:6144
    v_cvt_pk_bf16_f32 v24, v52, v60
    v_cvt_pk_bf16_f32 v25, v68, v76
    ds_write_b64 v3, v[24:25] offset:8192
    v_cvt_pk_bf16_f32 v26, v53, v61
    v_cvt_pk_bf16_f32 v27, v69, v77
    ds_write_b64 v3, v[26:27] offset:10240
    v_cvt_pk_bf16_f32 v28, v54, v62
    v_cvt_pk_bf16_f32 v29, v70, v78
    ds_write_b64 v3, v[28:29] offset:12288
    v_cvt_pk_bf16_f32 v30, v55, v63
    v_cvt_pk_bf16_f32 v31, v71, v79
    ds_write_b64 v3, v[30:31] offset:14336
    v_mov_b32 v4, 34816
    v_mov_b32 v5, 1
    s_waitcnt lgkmcnt(0)
    s_mov_b64 exec, 1
    ds_add_u32 v4, v5
    s_mov_b64 exec, -1
.b1_phaseB:
    s_mov_b32 s48, s40
    s_and_b32 s49, s41, 0xffff
    s_mov_b32 s50, 0x400000
    s_mov_b32 s51, 0x00020000
    v_mov_b32 v4, 34816
.spin_2:
    ds_read_b32 v5, v4
    s_waitcnt lgkmcnt(0)
    v_readfirstlane_b32 s4, v5
    s_nop 1
    s_cmp_ge_u32 s4, 4
    s_cbranch_scc1 .spun_3
    s_sleep 0
    s_branch .spin_2
.spun_3:
    ds_read_b64_tr_b16 v[16:17], v154 offset:0
    ds_read_b64_tr_b16 v[18:19], v154 offset:512
    ds_read_b64_tr_b16 v[20:21], v154 offset:1024
    ds_read_b64_tr_b16 v[22:23], v154 offset:1536
    ds_read_b64_tr_b16 v[24:25], v154 offset:2048
    ds_read_b64_tr_b16 v[26:27], v154 offset:2560
    ds_read_b64_tr_b16 v[28:29], v154 offset:3072
    ds_read_b64_tr_b16 v[30:31], v154 offset:3584
    s_waitcnt lgkmcnt(4)
    v_mfma_f32_32x32x16_bf16 v[32:47], v[16:19], v[80:83], 0
    v_mfma_f32_32x32x16_bf16 v[48:63], v[16:19], v[96:99], 0
    v_mfma_f32_32x32x16_bf16 v[32:47], v[20:23], v[84:87], v[32:47]
    v_mfma_f32_32x32x16_bf16 v[48:63], v[20:23], v[100:103], v[48:63]
    s_waitcnt lgkmcnt(0)
    s_cmp_eq_u32 s15, 0
    s_cbranch_scc1 .b1_real1
    v_mfma_f32_32x32x16_bf16 v[32:47], v[24:27], v[88:91], v[32:47]
    v_mfma_f32_32x32x16_bf16 v[48:63], v[24:27], v[80:83], v[48:63]
    v_mfma_f32_32x32x16_bf16 v[32:47], v[28:31], v[92:95], v[32:47]
    v_mfma_f32_32x32x16_bf16 v[48:63], v[28:31], v[84:87], v[48:63]
.b1_real1:
    s_nop 11
    v_pk_mul_f32 v[64:65], v[48:49], v[136:137]
    v_pk_mul_f32 v[136:137], v[32:33], v[136:137]
    v_pk_mul_f32 v[66:67], v[50:51], v[138:139]
    v_pk_mul_f32 v[138:139], v[34:35], v[138:139]
    v_pk_fma_f32 v[64:65], v[32:33], v[120:121], v[64:65]
    v_pk_fma_f32 v[136:137], v[48:49], v[120:121], v[136:137] neg_lo:[0,0,1] neg_hi:[0,0,1]
    v_pk_fma_f32 v[66:67], v[34:35], v[122:123], v[66:67]
    v_pk_fma_f32 v[138:139], v[50:51], v[122:123], v[138:139] neg_lo:[0,0,1] neg_hi:[0,0,1]
    v_pk_mul_f32 v[68:69], v[52:53], v[140:141]
    v_pk_mul_f32 v[140:141], v[36:37], v[140:141]
    v_pk_mul_f32 v[70:71], v[54:55], v[142:143]
    v_pk_mul_f32 v[142:143], v[38:39], v[142:143]
    v_pk_fma_f32 v[68:69], v[36:37], v[124:125], v[68:69]
    v_pk_fma_f32 v[140:141], v[52:53], v[124:125], v[140:141] neg_lo:[0,0,1] neg_hi:[0,0,1]
    v_pk_fma_f32 v[70:71], v[38:39], v[126:127], v[70:71]
    v_pk_fma_f32 v[142:143], v[54:55], v[126:127], v[142:143] neg_lo:[0,0,1] neg_hi:[0,0,1]
    v_cvt_pk_bf16_f32 v16, v64, v65
    v_cvt_pk_bf16_f32 v24, v136, v137
    v_cvt_pk_bf16_f32 v17, v66, v67
    v_cvt_pk_bf16_f32 v25, v138, v139
    v_cvt_pk_bf16_f32 v18, v68, v69
    v_cvt_pk_bf16_f32 v26, v140, v141
    v_cvt_pk_bf16_f32 v19, v70, v71
    v_cvt_pk_bf16_f32 v27, v142, v143
    v_pk_mul_f32 v[64:65], v[56:57], v[144:145]
    v_pk_mul_f32 v[144:145], v[40:41], v[144:145]
    v_pk_mul_f32 v[66:67], v[58:59], v[146:147]
    v_pk_mul_f32 v[146:147], v[42:43], v[146:147]
    v_pk_fma_f32 v[64:65], v[40:41], v[128:129], v[64:65]
    v_pk_fma_f32 v[144:145], v[56:57], v[128:129], v[144:145] neg_lo:[0,0,1] neg_hi:[0,0,1]
    v_pk_fma_f32 v[66:67], v[42:43], v[130:131], v[66:67]
    v_pk_fma_f32 v[146:147], v[58:59], v[130:131], v[146:147] neg_lo:[0,0,1] neg_hi:[0,0,1]
    v_pk_mul_f32 v[68:69], v[60:61], v[148:149]
    v_pk_mul_f32 v[148:149], v[44:45], v[148:149]
    v_pk_mul_f32 v[70:71], v[62:63], v[150:151]
    v_pk_mul_f32 v[150:151], v[46:47], v[150:151]
    v_pk_fma_f32 v[68:69], v[44:45], v[132:133], v[68:69]
    v_pk_fma_f32 v[148:149], v[60:61], v[132:133], v[148:149] neg_lo:[0,0,1] neg_hi:[0,0,1]
    v_pk_fma_f32 v[70:71], v[46:47], v[134:135], v[70:71]
    v_pk_fma_f32 v[150:151], v[62:63], v[134:135], v[150:151] neg_lo:[0,0,1] neg_hi:[0,0,1]
    v_cvt_pk_bf16_f32 v20, v64, v65
    v_cvt_pk_bf16_f32 v28, v144, v145
    v_cvt_pk_bf16_f32 v21, v66, v67
    v_cvt_pk_bf16_f32 v29, v146, v147
    v_cvt_pk_bf16_f32 v22, v68, v69
    v_cvt_pk_bf16_f32 v30, v148, v149
    v_cvt_pk_bf16_f32 v23, v70, v71
    v_cvt_pk_bf16_f32 v31, v150, v151
    v_mfma_f32_32x32x16_bf16 v[32:47], v[80:83], v[16:19], 0
    v_mfma_f32_32x32x16_bf16 v[48:63], v[104:107], v[24:27], 0
    v_mfma_f32_32x32x16_bf16 v[32:47], v[88:91], v[24:27], v[32:47]
    v_mfma_f32_32x32x16_bf16 v[48:63], v[112:115], v[16:19], v[48:63]
    v_mfma_f32_32x32x16_bf16 v[32:47], v[84:87], v[20:23], v[32:47]
    v_mfma_f32_32x32x16_bf16 v[48:63], v[108:111], v[28:31], v[48:63]
    v_mfma_f32_32x32x16_bf16 v[32:47], v[92:95], v[28:31], v[32:47]
    v_mfma_f32_32x32x16_bf16 v[48:63], v[116:119], v[20:23], v[48:63]
    v_mov_b32 v4, 34868
.spin_4:
    ds_read_b32 v5, v4
    s_waitcnt lgkmcnt(0)
    v_readfirstlane_b32 s14, v5
    s_nop 1
    s_cmp_ge_u32 s14, 1
    s_cbranch_scc1 .spun_5
    s_sleep 1
    s_branch .spin_4
.spun_5:
    s_and_b32 s14, s14, 0xfcfcfcd8
    s_or_b32 s14, s14, 0x18
    s_mov_b32 s7, 0xfffefffe
    v_lshrrev_b32 v166, v166, s14
    v_and_b32 v4, 4, v166
    v_and_b32 v166, 1, v166
    v_lshl_or_b32 v166, v4, 14, v166
    v_lshrrev_b32 v167, v167, s14
    v_and_b32 v4, 4, v167
    v_and_b32 v167, 1, v167
    v_lshl_or_b32 v167, v4, 14, v167
    s_cmp_eq_u32 s15, 0
    s_cbranch_scc0 .b1_cplx2
    s_mov_b64 exec, 1
    v_mov_b32 v48, v40
    s_mov_b64 exec, -1
    s_branch .b1_lo
.b1_cplx2:
    v_cvt_pk_bf16_f32 v72, v40, v56
    v_and_or_b32 v72, v72, s7, v167
    buffer_store_dword v72, v165, s[48:51], 0 offen offset:1408 sc1
    v_cvt_pk_bf16_f32 v73, v41, v57
    v_and_or_b32 v73, v73, s7, v167
    buffer_store_dword v73, v165, s[48:51], 0 offen offset:1280 sc1
    v_cvt_pk_bf16_f32 v74, v42, v58
    v_and_or_b32 v74, v74, s7, v167
    buffer_store_dword v74, v165, s[48:51], 0 offen offset:1152 sc1
    v_cvt_pk_bf16_f32 v75, v43, v59
    v_and_or_b32 v75, v75, s7, v167
    buffer_store_dword v75, v165, s[48:51], 0 offen offset:1024 sc1
    v_cvt_pk_bf16_f32 v76, v44, v60
    v_and_or_b32 v76, v76, s7, v167
    buffer_store_dword v76, v165, s[48:51], 0 offen offset:384 sc1
    v_cvt_pk_bf16_f32 v77, v45, v61
    v_and_or_b32 v77, v77, s7, v167
    buffer_store_dword v77, v165, s[48:51], 0 offen offset:256 sc1
    v_cvt_pk_bf16_f32 v78, v46, v62
    v_and_or_b32 v78, v78, s7, v167
    buffer_store_dword v78, v165, s[48:51], 0 offen offset:128 sc1
    v_cvt_pk_bf16_f32 v79, v47, v63
    v_and_or_b32 v79, v79, s7, v167
    buffer_store_dword v79, v165, s[48:51], 0 offen offset:0 sc1
.b1_lo:
    v_cvt_pk_bf16_f32 v64, v32, v48
    v_and_or_b32 v64, v64, s7, v166
    buffer_store_dword v64, v164, s[48:51], 0 offen offset:0 sc1
    v_cvt_pk_bf16_f32 v65, v33, v49
    v_and_or_b32 v65, v65, s7, v166
    buffer_store_dword v65, v164, s[48:51], 0 offen offset:128 sc1
    v_cvt_pk_bf16_f32 v66, v34, v50
    v_and_or_b32 v66, v66, s7, v166
    buffer_store_dword v66, v164, s[48:51], 0 offen offset:256 sc1
    v_cvt_pk_bf16_f32 v67, v35, v51
    v_and_or_b32 v67, v67, s7, v166
    buffer_store_dword v67, v164, s[48:51], 0 offen offset:384 sc1
    v_cvt_pk_bf16_f32 v68, v36, v52
    v_and_or_b32 v68, v68, s7, v166
    buffer_store_dword v68, v164, s[48:51], 0 offen offset:1024 sc1
    v_cvt_pk_bf16_f32 v69, v37, v53
    v_and_or_b32 v69, v69, s7, v166
    buffer_store_dword v69, v164, s[48:51], 0 offen offset:1152 sc1
    v_cvt_pk_bf16_f32 v70, v38, v54
    v_and_or_b32 v70, v70, s7, v166
    buffer_store_dword v70, v164, s[48:51], 0 offen offset:1280 sc1
    v_cvt_pk_bf16_f32 v71, v39, v55
    v_and_or_b32 v71, v71, s7, v166
    buffer_store_dword v71, v164, s[48:51], 0 offen offset:1408 sc1
    v_mov_b32 v4, 34820
    v_mov_b32 v5, 1
    s_waitcnt lgkmcnt(0)
    s_mov_b64 exec, 1
    ds_add_u32 v4, v5
    s_mov_b64 exec, -1
    s_cmp_eq_u32 s3, 4
    s_cbranch_scc1 .b3_start
.b2_start:
    s_and_b32 s12, s2, 7
    s_lshr_b32 s13, s2, 3
    v_and_b32 v3, 15, v2
    v_lshrrev_b32 v4, 4, v2
    s_setprio 0
    s_lshl_b32 s11, s12, 5
    s_add_u32 s11, s11, s13
    s_lshl_b32 s11, s11, 14
    v_lshlrev_b32 v5, 4, v2
    s_lshl_b32 s4, s3, 12
    s_add_u32 s10, s4, 0
    s_add_u32 s11, s11, s4
    v_add_u32 v163, s10, v5
    v_bfe_u32 v15, v3, 2, 2
    v_add_u32 v15, s3, v15
    v_and_b32 v15, 3, v15
    v_lshlrev_b32 v15, 4, v15
    v_lshl_add_u32 v15, v3, 6, v15
    v_lshl_add_u32 v15, v4, 12, v15
    v_add_u32 v162, 0, v15
    v_cvt_f32_u32 v64, v3
    v_lshlrev_b32 v65, 2, v4
    v_cvt_f32_u32 v65, v65
    v_cvt_f32_u32 v76, s12
    v_mul_f32 v76, 0x3c000000, v76
    v_mul_f32 v77, 0x3d800000, v64
    v_add_f32 v66, v77, v76
    v_mul_f32 v76, v76, v64
    v_mul_f32 v67, v65, v66
    v_mul_f32 v70, v65, v77
    v_cos_f32 v68, v67
    v_sin_f32 v69, v67
    v_add_f32 v73, v70, v76
    v_cos_f32 v71, v70
    v_sin_f32 v72, v70
    v_mul_f32 v67, 0x3d800000, v67
    v_cos_f32 v74, v73
    v_sin_f32 v75, v73
    v_mul_f32 v73, 0x3d800000, v73
    v_cvt_pk_bf16_f32 v16, v68, v69
    v_cvt_pk_bf16_f32 v20, -v69, v68
    v_cos_f32 v68, v67
    v_sin_f32 v69, v67
    v_cvt_pk_bf16_f32 v24, v71, v72
    v_cvt_pk_bf16_f32 v28, -v72, v71
    v_cvt_pk_bf16_f32 v32, v71, -v72
    v_cvt_pk_bf16_f32 v36, v72, v71
    v_cos_f32 v56, v73
    v_sin_f32 v60, v73
    v_cvt_pk_bf16_f32 v40, v74, -v75
    v_cvt_pk_bf16_f32 v44, v75, v74
    v_mul_f32 v48, 0x35800000, v68
    v_mul_f32 v52, 0x35800000, v69
    v_add_f32 v65, 1.0, v65
    v_mul_f32 v67, v65, v66
    v_mul_f32 v70, v65, v77
    v_cos_f32 v68, v67
    v_sin_f32 v69, v67
    v_add_f32 v73, v70, v76
    v_cos_f32 v71, v70
    v_sin_f32 v72, v70
    v_mul_f32 v67, 0x3d800000, v67
    v_cos_f32 v74, v73
    v_sin_f32 v75, v73
    v_mul_f32 v73, 0x3d800000, v73
    v_cvt_pk_bf16_f32 v17, v68, v69
    v_cvt_pk_bf16_f32 v21, -v69, v68
    v_cos_f32 v68, v67
    v_sin_f32 v69, v67
    v_cvt_pk_bf16_f32 v25, v71, v72
    v_cvt_pk_bf16_f32 v29, -v72, v71
    v_cvt_pk_bf16_f32 v33, v71, -v72
    v_cvt_pk_bf16_f32 v37, v72, v71
    v_cos_f32 v57, v73
    v_sin_f32 v61, v73
    v_cvt_pk_bf16_f32 v41, v74, -v75
    v_cvt_pk_bf16_f32 v45, v75, v74
    v_mul_f32 v49, 0x35800000, v68
    v_mul_f32 v53, 0x35800000, v69
    v_add_f32 v65, 1.0, v65
    v_mul_f32 v67, v65, v66
    v_mul_f32 v70, v65, v77
    v_cos_f32 v68, v67
    v_sin_f32 v69, v67
    v_add_f32 v73, v70, v76
    v_cos_f32 v71, v70
    v_sin_f32 v72, v70
    v_mul_f32 v67, 0x3d800000, v67
    v_cos_f32 v74, v73
    v_sin_f32 v75, v73
    v_mul_f32 v73, 0x3d800000, v73
    v_cvt_pk_bf16_f32 v18, v68, v69
    v_cvt_pk_bf16_f32 v22, -v69, v68
    v_cos_f32 v68, v67
    v_sin_f32 v69, v67
    v_cvt_pk_bf16_f32 v26, v71, v72
    v_cvt_pk_bf16_f32 v30, -v72, v71
    v_cvt_pk_bf16_f32 v34, v71, -v72
    v_cvt_pk_bf16_f32 v38, v72, v71
    v_cos_f32 v58, v73
    v_sin_f32 v62, v73
    v_cvt_pk_bf16_f32 v42, v74, -v75
    v_cvt_pk_bf16_f32 v46, v75, v74
    v_mul_f32 v50, 0x35800000, v68
    v_mul_f32 v54, 0x35800000, v69
    v_add_f32 v65, 1.0, v65
    v_mul_f32 v67, v65, v66
    v_mul_f32 v70, v65, v77
    v_cos_f32 v68, v67
    v_sin_f32 v69, v67
    v_add_f32 v73, v70, v76
    v_cos_f32 v71, v70
    v_sin_f32 v72, v70
    v_mul_f32 v67, 0x3d800000, v67
    v_cos_f32 v74, v73
    v_sin_f32 v75, v73
    v_mul_f32 v73, 0x3d800000, v73
    v_cvt_pk_bf16_f32 v19, v68, v69
    v_cvt_pk_bf16_f32 v23, -v69, v68
    v_cos_f32 v68, v67
    v_sin_f32 v69, v67
    v_cvt_pk_bf16_f32 v27, v71, v72
    v_cvt_pk_bf16_f32 v31, -v72, v71
    v_cvt_pk_bf16_f32 v35, v71, -v72
    v_cvt_pk_bf16_f32 v39, v72, v71
    v_cos_f32 v59, v73
    v_sin_f32 v63, v73
    v_cvt_pk_bf16_f32 v43, v74, -v75
    v_cvt_pk_bf16_f32 v47, v75, v74
    v_mul_f32 v51, 0x35800000, v68
    v_mul_f32 v55, 0x35800000, v69
    v_add_f32 v65, 1.0, v65
    s_mov_b32 s7, 0xffff0000
    s_mov_b32 s68, 0
    s_cmp_ge_u32 s12, 5
    s_cbranch_scc1 .b2_sp_hi
    s_or_b32 s4, s13, s3
    s_cmp_lg_u32 s4, 0
    s_cbranch_scc1 .b2_sp_done
    s_and_b32 s4, s12, 3
    s_cmp_eq_u32 s4, 0
    s_cselect_b32 s68, 3, 1
    s_branch .b2_sp_done
.b2_sp_hi:
    s_cmp_lg_u32 s13, 31
    s_cbranch_scc1 .b2_sp_done
    s_cmp_lg_u32 s3, 3
    s_cbranch_scc1 .b2_sp_done
    s_mov_b32 s68, 2
.b2_sp_done:
    s_mov_b32 s44, s40
    s_and_b32 s45, s41, 0xffff
    s_mov_b32 s46, 0x400000
    s_mov_b32 s47, 0x00020000
    s_mov_b32 s48, s40
    s_and_b32 s49, s41, 0xffff
    s_mov_b32 s50, 0x400000
    s_mov_b32 s51, 0x00020000
    v_lshrrev_b32 v160, 2, v2
    v_lshlrev_b32 v160, 14, v160
    v_and_b32 v9, 3, v2
    v_lshl_add_u32 v160, v9, 4, v160
    s_lshl_b32 s11, s12, 11
    s_lshl_b32 s5, s13, 6
    s_add_u32 s11, s11, s5
    s_lshl_b32 s5, s3, 20
    s_add_u32 s11, s11, s5
    v_and_b32 v8, 3, v2
    v_lshlrev_b32 v8, 3, v8
    v_lshrrev_b32 v8, v8, s14
    v_and_b32 v9, 12, v8
    v_lshlrev_b32 v161, 6, v9
    v_and_b32 v9, 0x30, v8
    v_lshl_or_b32 v161, v9, 12, v161
    v_and_b32 v9, 0xc0, v8
    v_lshl_or_b32 v161, v9, 18, v161
    s_mov_b32 s60, 0x06040200
    s_mov_b32 s61, 0x01010101
    s_mov_b32 s62, 0x03030303
    s_mov_b32 s63, 524288
    s_add_u32 s64, s11, 262144
    s_add_u32 s65, s11, 524288
    s_add_u32 s66, s11, 786432
    s_mov_b64 s[52:53], -1
    s_mov_b64 s[54:55], -1
    s_mov_b64 s[56:57], -1
    s_mov_b64 s[58:59], -1
    s_waitcnt vmcnt(0)
    v_mov_b32 v10, 34820
.spin_6:
    ds_read_b32 v11, v10
    s_waitcnt lgkmcnt(0)
    v_readfirstlane_b32 s4, v11
    s_nop 1
    s_cmp_ge_u32 s4, 5
    s_cbranch_scc1 .spun_7
    s_sleep 1
    s_branch .spin_6
.spun_7:
    s_setprio 2
    s_mov_b32 s4, 0xf
    s_mov_b32 s5, 0x0
.b2_samp:
    s_mov_b64 exec, s[4:5]
    buffer_load_dwordx4 v[64:67], v160, s[44:47], s66 offen sc1
    s_waitcnt vmcnt(0)
    v_perm_b32 v8, v65, v64, s60
    v_perm_b32 v9, v67, v66, s60
    v_lshlrev_b32 v9, 1, v9
    v_bfi_b32 v8, s61, v8, v9
    v_and_b32 v8, s62, v8
    v_cmp_ne_u32 s[4:5], v8, v161
    s_sub_u32 s63, s63, 1
    s_cmp_eq_u32 s63, 0
    s_cbranch_scc1 .b2_sampd
    s_wqm_b64 s[4:5], s[4:5]
    s_cbranch_scc1 .b2_samp
.b2_sampd:
    s_mov_b32 s63, 524288
    s_mov_b64 exec, -1
    buffer_load_dwordx4 v[64:67], v160, s[44:47], s11 offen sc1
    buffer_load_dwordx4 v[68:71], v160, s[44:47], s64 offen sc1
    buffer_load_dwordx4 v[72:75], v160, s[44:47], s65 offen sc1
    buffer_load_dwordx4 v[76:79], v160, s[44:47], s66 offen sc1
    v_mov_b32 v10, 34836
.spin_8:
    ds_read_b32 v11, v10
    s_waitcnt lgkmcnt(0)
    v_readfirstlane_b32 s4, v11
    s_nop 1
    s_cmp_ge_u32 s4, 1
    s_cbranch_scc1 .spun_9
    s_sleep 0
    s_branch .spin_8
.spun_9:
    ds_read_b128 v[80:83], v162 offset:16384
    ds_read_b128 v[84:87], v162 offset:17408
    ds_read_b128 v[88:91], v162 offset:18432
    ds_read_b128 v[92:95], v162 offset:19456
    s_waitcnt lgkmcnt(3)
    v_lshlrev_b32 v112, 16, v80
    v_and_b32 v120, s7, v80
    v_lshlrev_b32 v128, 16, v81
    v_and_b32 v136, s7, v81
    v_lshlrev_b32 v116, 16, v82
    v_and_b32 v124, s7, v82
    v_lshlrev_b32 v132, 16, v83
    v_and_b32 v140, s7, v83
    s_waitcnt lgkmcnt(2)
    v_lshlrev_b32 v113, 16, v84
    v_and_b32 v121, s7, v84
    v_lshlrev_b32 v129, 16, v85
    v_and_b32 v137, s7, v85
    v_lshlrev_b32 v117, 16, v86
    v_and_b32 v125, s7, v86
    v_lshlrev_b32 v133, 16, v87
    v_and_b32 v141, s7, v87
    s_waitcnt lgkmcnt(1)
    v_lshlrev_b32 v114, 16, v88
    v_and_b32 v122, s7, v88
    v_lshlrev_b32 v130, 16, v89
    v_and_b32 v138, s7, v89
    v_lshlrev_b32 v118, 16, v90
    v_and_b32 v126, s7, v90
    v_lshlrev_b32 v134, 16, v91
    v_and_b32 v142, s7, v91
    s_waitcnt lgkmcnt(0)
    v_lshlrev_b32 v115, 16, v92
    v_and_b32 v123, s7, v92
    v_lshlrev_b32 v131, 16, v93
    v_and_b32 v139, s7, v93
    v_lshlrev_b32 v119, 16, v94
    v_and_b32 v127, s7, v94
    v_lshlrev_b32 v135, 16, v95
    v_and_b32 v143, s7, v95
    s_cmp_eq_u32 s68, 0
    s_cbranch_scc1 .b2_nocw
    v_lshl_add_u32 v8, v4, 6, v3
    s_cmp_eq_u32 s12, 0
    s_cselect_b32 s4, 1, 0
    s_add_u32 s4, s4, 255
    v_sub_u32 v9, s4, v8
    s_cmp_eq_u32 s68, 2
    s_cselect_b32 s4, 1024, 0
    v_lshlrev_b32 v8, 2, v8
    v_add_u32 v8, 32768, v8
    v_subrev_u32 v10, 0, v9
    v_and_b32 v10, 255, v10
    v_lshlrev_b32 v10, 2, v10
    v_add_u32 v10, 32768, v10
    v_add_u32 v11, s4, v10
    ds_read_b32 v144, v11
    ds_read_b32 v148, v8 offset:1024
    ds_read_b32 v152, v10 offset:1024
    v_subrev_u32 v10, 16, v9
    v_and_b32 v10, 255, v10
    v_lshlrev_b32 v10, 2, v10
    v_add_u32 v10, 32768, v10
    v_add_u32 v11, s4, v10
    ds_read_b32 v145, v11
    ds_read_b32 v149, v8 offset:1088
    ds_read_b32 v153, v10 offset:1024
    v_subrev_u32 v10, 32, v9
    v_and_b32 v10, 255, v10
    v_lshlrev_b32 v10, 2, v10
    v_add_u32 v10, 32768, v10
    v_add_u32 v11, s4, v10
    ds_read_b32 v146, v11
    ds_read_b32 v150, v8 offset:1152
    ds_read_b32 v154, v10 offset:1024
    v_subrev_u32 v10, 48, v9
    v_and_b32 v10, 255, v10
    v_lshlrev_b32 v10, 2, v10
    v_add_u32 v10, 32768, v10
    v_add_u32 v11, s4, v10
    ds_read_b32 v147, v11
    ds_read_b32 v151, v8 offset:1216
    ds_read_b32 v155, v10 offset:1024
.b2_nocw:
.b2_poll:
    s_waitcnt vmcnt(0)
    s_mov_b64 exec, s[52:53]
    ds_write_b128 v163, v[64:67] offset:0
    v_perm_b32 v8, v65, v64, s60
    v_perm_b32 v9, v67, v66, s60
    v_lshlrev_b32 v9, 1, v9
    v_bfi_b32 v8, s61, v8, v9
    v_and_b32 v8, s62, v8
    v_cmp_ne_u32 s[52:53], v8, v161
    s_mov_b64 exec, s[54:55]
    ds_write_b128 v163, v[68:71] offset:1024
    v_perm_b32 v8, v69, v68, s60
    v_perm_b32 v9, v71, v70, s60
    v_lshlrev_b32 v9, 1, v9
    v_bfi_b32 v8, s61, v8, v9
    v_and_b32 v8, s62, v8
    v_cmp_ne_u32 s[54:55], v8, v161
    s_mov_b64 exec, s[56:57]
    ds_write_b128 v163, v[72:75] offset:2048
    v_perm_b32 v8, v73, v72, s60
    v_perm_b32 v9, v75, v74, s60
    v_lshlrev_b32 v9, 1, v9
    v_bfi_b32 v8, s61, v8, v9
    v_and_b32 v8, s62, v8
    v_cmp_ne_u32 s[56:57], v8, v161
    s_mov_b64 exec, s[58:59]
    ds_write_b128 v163, v[76:79] offset:3072
    v_perm_b32 v8, v77, v76, s60
    v_perm_b32 v9, v79, v78, s60
    v_lshlrev_b32 v9, 1, v9
    v_bfi_b32 v8, s61, v8, v9
    v_and_b32 v8, s62, v8
    v_cmp_ne_u32 s[58:59], v8, v161
    s_or_b64 s[4:5], s[52:53], s[54:55]
    s_nop 0
    s_or_b64 vcc, s[56:57], s[58:59]
    s_or_b64 s[4:5], s[4:5], vcc
    s_cbranch_scc0 .b2_got
    s_sub_u32 s63, s63, 1
    s_cmp_eq_u32 s63, 0
    s_cbranch_scc1 .b2_got
    s_wqm_b64 s[52:53], s[52:53]
    s_mov_b64 exec, s[52:53]
    buffer_load_dwordx4 v[64:67], v160, s[44:47], s11 offen sc1
    s_wqm_b64 s[54:55], s[54:55]
    s_mov_b64 exec, s[54:55]
    buffer_load_dwordx4 v[68:71], v160, s[44:47], s64 offen sc1
    s_wqm_b64 s[56:57], s[56:57]
    s_mov_b64 exec, s[56:57]
    buffer_load_dwordx4 v[72:75], v160, s[44:47], s65 offen sc1
    s_wqm_b64 s[58:59], s[58:59]
    s_mov_b64 exec, s[58:59]
    buffer_load_dwordx4 v[76:79], v160, s[44:47], s66 offen sc1
    s_branch .b2_poll
.b2_got:
    s_mov_b64 exec, -1
    v_mov_b32 v10, 34832
    v_mov_b32 v11, 1
    s_waitcnt lgkmcnt(0)
    s_mov_b64 exec, 1
    ds_add_u32 v10, v11
    s_mov_b64 exec, -1
    v_mov_b32 v10, 34832
.spin_10:
    ds_read_b32 v11, v10
    s_waitcnt lgkmcnt(0)
    v_readfirstlane_b32 s4, v11
    s_nop 1
    s_cmp_ge_u32 s4, 4
    s_cbranch_scc1 .spun_11
    s_sleep 0
    s_branch .spin_10
.spun_11:
    ds_read_b128 v[80:83], v162 offset:0
    ds_read_b128 v[84:87], v162 offset:1024
    ds_read_b128 v[88:91], v162 offset:2048
    ds_read_b128 v[92:95], v162 offset:3072
    s_mov_b32 s60, 0xfffefffe
    v_mov_b32 v161, 0x10000
    s_waitcnt lgkmcnt(3)
    v_and_or_b32 v64, v80, s60, v161
    v_and_or_b32 v68, v81, s60, v161
    v_and_or_b32 v72, v82, s60, v161
    v_and_or_b32 v76, v83, s60, v161
    s_waitcnt lgkmcnt(2)
    v_and_or_b32 v65, v84, s60, v161
    v_and_or_b32 v69, v85, s60, v161
    v_and_or_b32 v73, v86, s60, v161
    v_and_or_b32 v77, v87, s60, v161
    s_waitcnt lgkmcnt(1)
    v_and_or_b32 v66, v88, s60, v161
    v_and_or_b32 v70, v89, s60, v161
    v_and_or_b32 v74, v90, s60, v161
    v_and_or_b32 v78, v91, s60, v161
    s_waitcnt lgkmcnt(0)
    v_and_or_b32 v67, v92, s60, v161
    v_and_or_b32 v71, v93, s60, v161
    v_and_or_b32 v75, v94, s60, v161
    v_and_or_b32 v79, v95, s60, v161
    v_mfma_f32_16x16x32_bf16 v[80:83], v[64:67], v[16:19], 0
    v_mfma_f32_16x16x32_bf16 v[84:87], v[64:67], v[20:23], 0
    v_mfma_f32_16x16x32_bf16 v[88:91], v[68:71], v[16:19], 0
    v_mfma_f32_16x16x32_bf16 v[92:95], v[68:71], v[20:23], 0
    v_mfma_f32_16x16x32_bf16 v[96:99], v[72:75], v[16:19], 0
    v_mfma_f32_16x16x32_bf16 v[100:103], v[72:75], v[20:23], 0
    v_mfma_f32_16x16x32_bf16 v[104:107], v[76:79], v[16:19], 0
    v_mfma_f32_16x16x32_bf16 v[108:111], v[76:79], v[20:23], 0
    s_nop 0
    v_mul_f32 v8, v80, v48
    v_mul_f32 v10, v84, v48
    v_mul_f32 v9, v81, v49
    v_mul_f32 v11, v85, v49
    v_fmac_f32 v8, v84, v52
    v_fma_f32 v10, -v80, v52, v10
    v_fmac_f32 v9, v85, v53
    v_fma_f32 v11, -v81, v53, v11
    v_cvt_pk_bf16_f32 v64, v8, v10
    v_cvt_pk_bf16_f32 v65, v9, v11
    v_mul_f32 v12, v82, v50
    v_mul_f32 v14, v86, v50
    v_mul_f32 v13, v83, v51
    v_mul_f32 v15, v87, v51
    v_fmac_f32 v12, v86, v54
    v_fma_f32 v14, -v82, v54, v14
    v_fmac_f32 v13, v87, v55
    v_fma_f32 v15, -v83, v55, v15
    v_cvt_pk_bf16_f32 v66, v12, v14
    v_cvt_pk_bf16_f32 v67, v13, v15
    v_mul_f32 v8, v88, v48
    v_mul_f32 v10, v92, v48
    v_mul_f32 v9, v89, v49
    v_mul_f32 v11, v93, v49
    v_fmac_f32 v8, v92, v52
    v_fma_f32 v10, -v88, v52, v10
    v_fmac_f32 v9, v93, v53
    v_fma_f32 v11, -v89, v53, v11
    v_cvt_pk_bf16_f32 v68, v8, v10
    v_cvt_pk_bf16_f32 v69, v9, v11
    v_mul_f32 v12, v90, v50
    v_mul_f32 v14, v94, v50
    v_mul_f32 v13, v91, v51
    v_mul_f32 v15, v95, v51
    v_fmac_f32 v12, v94, v54
    v_fma_f32 v14, -v90, v54, v14
    v_fmac_f32 v13, v95, v55
    v_fma_f32 v15, -v91, v55, v15
    v_cvt_pk_bf16_f32 v70, v12, v14
    v_cvt_pk_bf16_f32 v71, v13, v15
    v_mul_f32 v8, v96, v48
    v_mul_f32 v10, v100, v48
    v_mul_f32 v9, v97, v49
    v_mul_f32 v11, v101, v49
    v_fmac_f32 v8, v100, v52
    v_fma_f32 v10, -v96, v52, v10
    v_fmac_f32 v9, v101, v53
    v_fma_f32 v11, -v97, v53, v11
    v_cvt_pk_bf16_f32 v72, v8, v10
    v_cvt_pk_bf16_f32 v73, v9, v11
    v_mul_f32 v12, v98, v50
    v_mul_f32 v14, v102, v50
    v_mul_f32 v13, v99, v51
    v_mul_f32 v15, v103, v51
    v_fmac_f32 v12, v102, v54
    v_fma_f32 v14, -v98, v54, v14
    v_fmac_f32 v13, v103, v55
    v_fma_f32 v15, -v99, v55, v15
    v_cvt_pk_bf16_f32 v74, v12, v14
    v_cvt_pk_bf16_f32 v75, v13, v15
    v_mul_f32 v8, v104, v48
    v_mul_f32 v10, v108, v48
    v_mul_f32 v9, v105, v49
    v_mul_f32 v11, v109, v49
    v_fmac_f32 v8, v108, v52
    v_fma_f32 v10, -v104, v52, v10
    v_fmac_f32 v9, v109, v53
    v_fma_f32 v11, -v105, v53, v11
    v_cvt_pk_bf16_f32 v76, v8, v10
    v_cvt_pk_bf16_f32 v77, v9, v11
    v_mul_f32 v12, v106, v50
    v_mul_f32 v14, v110, v50
    v_mul_f32 v13, v107, v51
    v_mul_f32 v15, v111, v51
    v_fmac_f32 v12, v110, v54
    v_fma_f32 v14, -v106, v54, v14
    v_fmac_f32 v13, v111, v55
    v_fma_f32 v15, -v107, v55, v15
    v_cvt_pk_bf16_f32 v78, v12, v14
    v_cvt_pk_bf16_f32 v79, v13, v15
    v_mfma_f32_16x16x32_bf16 v[80:83], v[24:27], v[64:67], 0
    v_mfma_f32_16x16x32_bf16 v[84:87], v[28:31], v[64:67], 0
    v_mfma_f32_16x16x32_bf16 v[88:91], v[24:27], v[68:71], 0
    v_mfma_f32_16x16x32_bf16 v[92:95], v[28:31], v[68:71], 0
    v_mfma_f32_16x16x32_bf16 v[96:99], v[24:27], v[72:75], 0
    v_mfma_f32_16x16x32_bf16 v[100:103], v[28:31], v[72:75], 0
    v_mfma_f32_16x16x32_bf16 v[104:107], v[24:27], v[76:79], 0
    v_mfma_f32_16x16x32_bf16 v[108:111], v[28:31], v[76:79], 0
    s_cmp_eq_u32 s68, 0
    s_cbranch_scc1 .b2_noreal
    s_cmp_eq_u32 s68, 2
    s_cbranch_scc1 .b2_patch_hi
    v_lshlrev_b32 v8, 16, v144
    v_and_b32 v9, s7, v144
    v_add_f32 v112, v112, v8
    v_sub_f32 v116, v116, v9
    v_lshlrev_b32 v8, 16, v145
    v_and_b32 v9, s7, v145
    v_add_f32 v113, v113, v8
    v_sub_f32 v117, v117, v9
    v_lshlrev_b32 v8, 16, v146
    v_and_b32 v9, s7, v146
    v_add_f32 v114, v114, v8
    v_sub_f32 v118, v118, v9
    v_lshlrev_b32 v8, 16, v147
    v_and_b32 v9, s7, v147
    v_add_f32 v115, v115, v8
    v_sub_f32 v119, v119, v9
    v_mul_f32 v112, 0.5, v112
    v_mul_f32 v113, 0.5, v113
    v_mul_f32 v114, 0.5, v114
    v_mul_f32 v115, 0.5, v115
    v_mul_f32 v116, 0.5, v116
    v_mul_f32 v117, 0.5, v117
    v_mul_f32 v118, 0.5, v118
    v_mul_f32 v119, 0.5, v119
    s_cmp_eq_u32 s68, 1
    s_cbranch_scc1 .b2_noreal
    v_lshl_add_u32 v8, v4, 6, v3
    s_lshr_b32 s4, s12, 2
    s_sub_u32 s4, 256, s4
    v_sub_u32 v9, s4, v8
    v_lshlrev_b32 v8, 2, v8
    v_add_u32 v8, 32768, v8
    ds_write_b32 v8, v80 offset:0
    ds_write_b32 v8, v84 offset:1024
    ds_write_b32 v8, v81 offset:64
    ds_write_b32 v8, v85 offset:1088
    ds_write_b32 v8, v82 offset:128
    ds_write_b32 v8, v86 offset:1152
    ds_write_b32 v8, v83 offset:192
    ds_write_b32 v8, v87 offset:1216
    v_subrev_u32 v10, 0, v9
    v_and_b32 v10, 255, v10
    v_lshlrev_b32 v10, 2, v10
    v_add_u32 v10, 32768, v10
    ds_read_b32 v16, v10
    ds_read_b32 v20, v10 offset:1024
    v_subrev_u32 v10, 16, v9
    v_and_b32 v10, 255, v10
    v_lshlrev_b32 v10, 2, v10
    v_add_u32 v10, 32768, v10
    ds_read_b32 v17, v10
    ds_read_b32 v21, v10 offset:1024
    v_subrev_u32 v10, 32, v9
    v_and_b32 v10, 255, v10
    v_lshlrev_b32 v10, 2, v10
    v_add_u32 v10, 32768, v10
    ds_read_b32 v18, v10
    ds_read_b32 v22, v10 offset:1024
    v_subrev_u32 v10, 48, v9
    v_and_b32 v10, 255, v10
    v_lshlrev_b32 v10, 2, v10
    v_add_u32 v10, 32768, v10
    ds_read_b32 v19, v10
    ds_read_b32 v23, v10 offset:1024
    v_lshlrev_b32 v12, 16, v148
    v_lshlrev_b32 v13, 16, v152
    v_and_b32 v14, s7, v148
    v_and_b32 v15, s7, v152
    v_add_f32 v12, v12, v13
    v_sub_f32 v14, v14, v15
    v_mul_f32 v12, 0x3e000000, v12
    v_mul_f32 v14, 0x3e000000, v14
    v_mul_f32 v112, 0x3e800000, v112
    v_mul_f32 v116, 0x3e800000, v116
    v_add_f32 v24, v112, v12
    v_add_f32 v28, v116, v14
    v_sub_f32 v48, v112, v12
    v_sub_f32 v52, v116, v14
    v_mov_b32 v112, 1.0
    v_mov_b32 v116, 0
    v_lshlrev_b32 v12, 16, v149
    v_lshlrev_b32 v13, 16, v153
    v_and_b32 v14, s7, v149
    v_and_b32 v15, s7, v153
    v_add_f32 v12, v12, v13
    v_sub_f32 v14, v14, v15
    v_mul_f32 v12, 0x3e000000, v12
    v_mul_f32 v14, 0x3e000000, v14
    v_mul_f32 v113, 0x3e800000, v113
    v_mul_f32 v117, 0x3e800000, v117
    v_add_f32 v25, v113, v12
    v_add_f32 v29, v117, v14
    v_sub_f32 v49, v113, v12
    v_sub_f32 v53, v117, v14
    v_mov_b32 v113, 1.0
    v_mov_b32 v117, 0
    v_lshlrev_b32 v12, 16, v150
    v_lshlrev_b32 v13, 16, v154
    v_and_b32 v14, s7, v150
    v_and_b32 v15, s7, v154
    v_add_f32 v12, v12, v13
    v_sub_f32 v14, v14, v15
    v_mul_f32 v12, 0x3e000000, v12
    v_mul_f32 v14, 0x3e000000, v14
    v_mul_f32 v114, 0x3e800000, v114
    v_mul_f32 v118, 0x3e800000, v118
    v_add_f32 v26, v114, v12
    v_add_f32 v30, v118, v14
    v_sub_f32 v50, v114, v12
    v_sub_f32 v54, v118, v14
    v_mov_b32 v114, 1.0
    v_mov_b32 v118, 0
    v_lshlrev_b32 v12, 16, v151
    v_lshlrev_b32 v13, 16, v155
    v_and_b32 v14, s7, v151
    v_and_b32 v15, s7, v155
    v_add_f32 v12, v12, v13
    v_sub_f32 v14, v14, v15
    v_mul_f32 v12, 0x3e000000, v12
    v_mul_f32 v14, 0x3e000000, v14
    v_mul_f32 v115, 0x3e800000, v115
    v_mul_f32 v119, 0x3e800000, v119
    v_add_f32 v27, v115, v12
    v_add_f32 v31, v119, v14
    v_sub_f32 v51, v115, v12
    v_sub_f32 v55, v119, v14
    v_mov_b32 v115, 1.0
    v_mov_b32 v119, 0
    s_waitcnt lgkmcnt(0)
    v_mul_f32 v8, v80, v24
    v_mul_f32 v9, v80, v28
    v_fma_f32 v8, -v84, v28, v8
    v_fmac_f32 v9, v84, v24
    v_fmac_f32 v8, v16, v48
    v_fmac_f32 v9, v16, v52
    v_fma_f32 v80, v20, v52, v8
    v_fma_f32 v84, -v20, v48, v9
    v_mul_f32 v8, v81, v25
    v_mul_f32 v9, v81, v29
    v_fma_f32 v8, -v85, v29, v8
    v_fmac_f32 v9, v85, v25
    v_fmac_f32 v8, v17, v49
    v_fmac_f32 v9, v17, v53
    v_fma_f32 v81, v21, v53, v8
    v_fma_f32 v85, -v21, v49, v9
    v_mul_f32 v8, v82, v26
    v_mul_f32 v9, v82, v30
    v_fma_f32 v8, -v86, v30, v8
    v_fmac_f32 v9, v86, v26
    v_fmac_f32 v8, v18, v50
    v_fmac_f32 v9, v18, v54
    v_fma_f32 v82, v22, v54, v8
    v_fma_f32 v86, -v22, v50, v9
    v_mul_f32 v8, v83, v27
    v_mul_f32 v9, v83, v31
    v_fma_f32 v8, -v87, v31, v8
    v_fmac_f32 v9, v87, v27
    v_fmac_f32 v8, v19, v51
    v_fmac_f32 v9, v19, v55
    v_fma_f32 v83, v23, v55, v8
    v_fma_f32 v87, -v23, v51, v9
    s_branch .b2_noreal
.b2_patch_hi:
    v_lshlrev_b32 v8, 16, v144
    v_and_b32 v9, s7, v144
    v_add_f32 v136, v136, v8
    v_sub_f32 v140, v140, v9
    v_lshlrev_b32 v8, 16, v145
    v_and_b32 v9, s7, v145
    v_add_f32 v137, v137, v8
    v_sub_f32 v141, v141, v9
    v_lshlrev_b32 v8, 16, v146
    v_and_b32 v9, s7, v146
    v_add_f32 v138, v138, v8
    v_sub_f32 v142, v142, v9
    v_lshlrev_b32 v8, 16, v147
    v_and_b32 v9, s7, v147
    v_add_f32 v139, v139, v8
    v_sub_f32 v143, v143, v9
    v_mul_f32 v136, 0.5, v136
    v_mul_f32 v137, 0.5, v137
    v_mul_f32 v138, 0.5, v138
    v_mul_f32 v139, 0.5, v139
    v_mul_f32 v140, 0.5, v140
    v_mul_f32 v141, 0.5, v141
    v_mul_f32 v142, 0.5, v142
    v_mul_f32 v143, 0.5, v143
.b2_noreal:
    v_mul_f32 v8, v80, v112
    v_mul_f32 v10, v84, v112
    v_mul_f32 v9, v81, v113
    v_mul_f32 v11, v85, v113
    v_fma_f32 v8, -v84, v116, v8
    v_fmac_f32 v10, v80, v116
    v_fma_f32 v9, -v85, v117, v9
    v_fmac_f32 v11, v81, v117
    v_cvt_pk_bf16_f32 v64, v8, v10
    v_cvt_pk_bf16_f32 v65, v9, v11
    v_mul_f32 v12, v82, v114
    v_mul_f32 v14, v86, v114
    v_mul_f32 v13, v83, v115
    v_mul_f32 v15, v87, v115
    v_fma_f32 v12, -v86, v118, v12
    v_fmac_f32 v14, v82, v118
    v_fma_f32 v13, -v87, v119, v13
    v_fmac_f32 v15, v83, v119
    v_cvt_pk_bf16_f32 v66, v12, v14
    v_cvt_pk_bf16_f32 v67, v13, v15
    v_mul_f32 v8, v88, v120
    v_mul_f32 v10, v92, v120
    v_mul_f32 v9, v89, v121
    v_mul_f32 v11, v93, v121
    v_fma_f32 v8, -v92, v124, v8
    v_fmac_f32 v10, v88, v124
    v_fma_f32 v9, -v93, v125, v9
    v_fmac_f32 v11, v89, v125
    v_cvt_pk_bf16_f32 v68, v8, v10
    v_cvt_pk_bf16_f32 v69, v9, v11
    v_mul_f32 v12, v90, v122
    v_mul_f32 v14, v94, v122
    v_mul_f32 v13, v91, v123
    v_mul_f32 v15, v95, v123
    v_fma_f32 v12, -v94, v126, v12
    v_fmac_f32 v14, v90, v126
    v_fma_f32 v13, -v95, v127, v13
    v_fmac_f32 v15, v91, v127
    v_cvt_pk_bf16_f32 v70, v12, v14
    v_cvt_pk_bf16_f32 v71, v13, v15
    v_mul_f32 v8, v96, v128
    v_mul_f32 v10, v100, v128
    v_mul_f32 v9, v97, v129
    v_mul_f32 v11, v101, v129
    v_fma_f32 v8, -v100, v132, v8
    v_fmac_f32 v10, v96, v132
    v_fma_f32 v9, -v101, v133, v9
    v_fmac_f32 v11, v97, v133
    v_cvt_pk_bf16_f32 v72, v8, v10
    v_cvt_pk_bf16_f32 v73, v9, v11
    v_mul_f32 v12, v98, v130
    v_mul_f32 v14, v102, v130
    v_mul_f32 v13, v99, v131
    v_mul_f32 v15, v103, v131
    v_fma_f32 v12, -v102, v134, v12
    v_fmac_f32 v14, v98, v134
    v_fma_f32 v13, -v103, v135, v13
    v_fmac_f32 v15, v99, v135
    v_cvt_pk_bf16_f32 v74, v12, v14
    v_cvt_pk_bf16_f32 v75, v13, v15
    v_mul_f32 v8, v104, v136
    v_mul_f32 v10, v108, v136
    v_mul_f32 v9, v105, v137
    v_mul_f32 v11, v109, v137
    v_fma_f32 v8, -v108, v140, v8
    v_fmac_f32 v10, v104, v140
    v_fma_f32 v9, -v109, v141, v9
    v_fmac_f32 v11, v105, v141
    v_cvt_pk_bf16_f32 v76, v8, v10
    v_cvt_pk_bf16_f32 v77, v9, v11
    v_mul_f32 v12, v106, v138
    v_mul_f32 v14, v110, v138
    v_mul_f32 v13, v107, v139
    v_mul_f32 v15, v111, v139
    v_fma_f32 v12, -v110, v142, v12
    v_fmac_f32 v14, v106, v142
    v_fma_f32 v13, -v111, v143, v13
    v_fmac_f32 v15, v107, v143
    v_cvt_pk_bf16_f32 v78, v12, v14
    v_cvt_pk_bf16_f32 v79, v13, v15
    v_mfma_f32_16x16x32_bf16 v[80:83], v[64:67], v[32:35], 0
    v_mfma_f32_16x16x32_bf16 v[84:87], v[64:67], v[36:39], 0
    v_mfma_f32_16x16x32_bf16 v[88:91], v[68:71], v[32:35], 0
    v_mfma_f32_16x16x32_bf16 v[92:95], v[68:71], v[36:39], 0
    v_mfma_f32_16x16x32_bf16 v[96:99], v[72:75], v[32:35], 0
    v_mfma_f32_16x16x32_bf16 v[100:103], v[72:75], v[36:39], 0
    v_mfma_f32_16x16x32_bf16 v[104:107], v[76:79], v[32:35], 0
    v_mfma_f32_16x16x32_bf16 v[108:111], v[76:79], v[36:39], 0
    s_nop 0
    v_mul_f32 v8, v80, v56
    v_mul_f32 v10, v84, v56
    v_mul_f32 v9, v81, v57
    v_mul_f32 v11, v85, v57
    v_fma_f32 v8, -v84, v60, v8
    v_fmac_f32 v10, v80, v60
    v_fma_f32 v9, -v85, v61, v9
    v_fmac_f32 v11, v81, v61
    v_cvt_pk_bf16_f32 v64, v8, v10
    v_cvt_pk_bf16_f32 v65, v9, v11
    v_mul_f32 v12, v82, v58
    v_mul_f32 v14, v86, v58
    v_mul_f32 v13, v83, v59
    v_mul_f32 v15, v87, v59
    v_fma_f32 v12, -v86, v62, v12
    v_fmac_f32 v14, v82, v62
    v_fma_f32 v13, -v87, v63, v13
    v_fmac_f32 v15, v83, v63
    v_cvt_pk_bf16_f32 v66, v12, v14
    v_cvt_pk_bf16_f32 v67, v13, v15
    v_mul_f32 v8, v88, v56
    v_mul_f32 v10, v92, v56
    v_mul_f32 v9, v89, v57
    v_mul_f32 v11, v93, v57
    v_fma_f32 v8, -v92, v60, v8
    v_fmac_f32 v10, v88, v60
    v_fma_f32 v9, -v93, v61, v9
    v_fmac_f32 v11, v89, v61
    v_cvt_pk_bf16_f32 v68, v8, v10
    v_cvt_pk_bf16_f32 v69, v9, v11
    v_mul_f32 v12, v90, v58
    v_mul_f32 v14, v94, v58
    v_mul_f32 v13, v91, v59
    v_mul_f32 v15, v95, v59
    v_fma_f32 v12, -v94, v62, v12
    v_fmac_f32 v14, v90, v62
    v_fma_f32 v13, -v95, v63, v13
    v_fmac_f32 v15, v91, v63
    v_cvt_pk_bf16_f32 v70, v12, v14
    v_cvt_pk_bf16_f32 v71, v13, v15
    v_mul_f32 v8, v96, v56
    v_mul_f32 v10, v100, v56
    v_mul_f32 v9, v97, v57
    v_mul_f32 v11, v101, v57
    v_fma_f32 v8, -v100, v60, v8
    v_fmac_f32 v10, v96, v60
    v_fma_f32 v9, -v101, v61, v9
    v_fmac_f32 v11, v97, v61
    v_cvt_pk_bf16_f32 v72, v8, v10
    v_cvt_pk_bf16_f32 v73, v9, v11
    v_mul_f32 v12, v98, v58
    v_mul_f32 v14, v102, v58
    v_mul_f32 v13, v99, v59
    v_mul_f32 v15, v103, v59
    v_fma_f32 v12, -v102, v62, v12
    v_fmac_f32 v14, v98, v62
    v_fma_f32 v13, -v103, v63, v13
    v_fmac_f32 v15, v99, v63
    v_cvt_pk_bf16_f32 v74, v12, v14
    v_cvt_pk_bf16_f32 v75, v13, v15
    v_mul_f32 v8, v104, v56
    v_mul_f32 v10, v108, v56
    v_mul_f32 v9, v105, v57
    v_mul_f32 v11, v109, v57
    v_fma_f32 v8, -v108, v60, v8
    v_fmac_f32 v10, v104, v60
    v_fma_f32 v9, -v109, v61, v9
    v_fmac_f32 v11, v105, v61
    v_cvt_pk_bf16_f32 v76, v8, v10
    v_cvt_pk_bf16_f32 v77, v9, v11
    v_mul_f32 v12, v106, v58
    v_mul_f32 v14, v110, v58
    v_mul_f32 v13, v107, v59
    v_mul_f32 v15, v111, v59
    v_fma_f32 v12, -v110, v62, v12
    v_fmac_f32 v14, v106, v62
    v_fma_f32 v13, -v111, v63, v13
    v_fmac_f32 v15, v107, v63
    v_cvt_pk_bf16_f32 v78, v12, v14
    v_cvt_pk_bf16_f32 v79, v13, v15
    v_mfma_f32_16x16x32_bf16 v[80:83], v[40:43], v[64:67], 0
    v_mfma_f32_16x16x32_bf16 v[84:87], v[44:47], v[64:67], 0
    v_mfma_f32_16x16x32_bf16 v[88:91], v[40:43], v[68:71], 0
    v_mfma_f32_16x16x32_bf16 v[92:95], v[44:47], v[68:71], 0
    v_mfma_f32_16x16x32_bf16 v[96:99], v[40:43], v[72:75], 0
    v_mfma_f32_16x16x32_bf16 v[100:103], v[44:47], v[72:75], 0
    v_mfma_f32_16x16x32_bf16 v[104:107], v[40:43], v[76:79], 0
    v_mfma_f32_16x16x32_bf16 v[108:111], v[44:47], v[76:79], 0
    s_nop 1
    v_cvt_pk_bf16_f32 v64, v80, v84
    s_nop 0
    v_cvt_pk_bf16_f32 v65, v88, v92
    s_nop 0
    v_cvt_pk_bf16_f32 v66, v96, v100
    s_nop 0
    v_cvt_pk_bf16_f32 v67, v104, v108
    ds_write_b128 v162, v[64:67] offset:0
    v_cvt_pk_bf16_f32 v68, v81, v85
    v_cvt_pk_bf16_f32 v69, v89, v93
    v_cvt_pk_bf16_f32 v70, v97, v101
    v_cvt_pk_bf16_f32 v71, v105, v109
    ds_write_b128 v162, v[68:71] offset:1024
    v_cvt_pk_bf16_f32 v72, v82, v86
    v_cvt_pk_bf16_f32 v73, v90, v94
    v_cvt_pk_bf16_f32 v74, v98, v102
    v_cvt_pk_bf16_f32 v75, v106, v110
    ds_write_b128 v162, v[72:75] offset:2048
    v_cvt_pk_bf16_f32 v76, v83, v87
    v_cvt_pk_bf16_f32 v77, v91, v95
    v_cvt_pk_bf16_f32 v78, v99, v103
    v_cvt_pk_bf16_f32 v79, v107, v111
    ds_write_b128 v162, v[76:79] offset:3072
    v_mov_b32 v10, 34840
    v_mov_b32 v11, 1
    s_waitcnt lgkmcnt(0)
    s_mov_b64 exec, 1
    ds_add_u32 v10, v11
    s_mov_b64 exec, -1
    v_mov_b32 v10, 34840
.spin_12:
    ds_read_b32 v11, v10
    s_waitcnt lgkmcnt(0)
    v_readfirstlane_b32 s4, v11
    s_nop 1
    s_cmp_ge_u32 s4, 4
    s_cbranch_scc1 .spun_13
    s_sleep 0
    s_branch .spin_12
.spun_13:
    ds_read_b128 v[64:67], v163 offset:0
    ds_read_b128 v[68:71], v163 offset:1024
    ds_read_b128 v[72:75], v163 offset:2048
    ds_read_b128 v[76:79], v163 offset:3072
    v_lshrrev_b32 v8, 2, v2
    v_lshlrev_b32 v8, 14, v8
    v_and_b32 v9, 3, v2
    v_lshl_add_u32 v8, v9, 4, v8
    s_lshl_b32 s4, s12, 11
    s_lshl_b32 s5, s13, 6
    s_add_u32 s4, s4, s5
    s_lshl_b32 s5, s3, 20
    s_add_u32 s4, s4, s5
    s_waitcnt lgkmcnt(3)
    v_or_b32 v64, 1, v64
    v_or_b32 v66, 1, v66
    buffer_store_dwordx4 v[64:67], v8, s[48:51], s4 offen sc1
    s_add_u32 s4, s4, 262144
    s_waitcnt lgkmcnt(2)
    v_or_b32 v68, 1, v68
    v_or_b32 v70, 1, v70
    buffer_store_dwordx4 v[68:71], v8, s[48:51], s4 offen sc1
    s_add_u32 s4, s4, 262144
    s_waitcnt lgkmcnt(1)
    v_or_b32 v72, 1, v72
    v_or_b32 v74, 1, v74
    buffer_store_dwordx4 v[72:75], v8, s[48:51], s4 offen sc1
    s_add_u32 s4, s4, 262144
    s_waitcnt lgkmcnt(0)
    v_or_b32 v76, 1, v76
    v_or_b32 v78, 1, v78
    buffer_store_dwordx4 v[76:79], v8, s[48:51], s4 offen sc1
    v_mov_b32 v10, 34828
    v_mov_b32 v11, 1
    s_waitcnt lgkmcnt(0)
    s_mov_b64 exec, 1
    ds_add_u32 v10, v11
    s_mov_b64 exec, -1
.b3_start:
    s_waitcnt vmcnt(8)
    s_setprio 0
    v_mov_b32 v4, 34928
.spin_14:
    ds_read_b32 v5, v4
    s_waitcnt lgkmcnt(0)
    v_readfirstlane_b32 s4, v5
    s_nop 1
    s_cmp_ge_u32 s4, 1
    s_cbranch_scc1 .spun_15
    s_sleep 4
    s_branch .spin_14
.spun_15:
    v_and_b32 v74, 31, v2
    v_cvt_f32_u32 v74, v74
    v_mul_f32 v74, 0x3d000000, v74
    v_lshrrev_b32 v75, 5, v2
    v_cvt_f32_u32 v75, v75
    v_mul_f32 v75, 4.0, v75
    v_mul_f32 v75, v75, v74
    v_mul_f32 v79, 0x40a00000, v74
    v_cos_f32 v77, v75
    v_sin_f32 v78, v75
    v_mul_f32 v76, 0x3d000000, v75
    v_cos_f32 v128, v76
    v_sin_f32 v144, v76
    v_add_f32 v75, v75, v74
    v_cvt_pk_bf16_f32 v80, v77, -v78
    v_cvt_pk_bf16_f32 v96, v78, v77
    v_cos_f32 v77, v75
    v_sin_f32 v78, v75
    v_mul_f32 v76, 0x3d000000, v75
    v_cos_f32 v129, v76
    v_sin_f32 v145, v76
    v_add_f32 v75, v75, v74
    v_cvt_pk_bf16_f32 v81, v77, -v78
    v_cvt_pk_bf16_f32 v97, v78, v77
    v_cos_f32 v77, v75
    v_sin_f32 v78, v75
    v_mul_f32 v76, 0x3d000000, v75
    v_cos_f32 v130, v76
    v_sin_f32 v146, v76
    v_add_f32 v75, v75, v74
    v_cvt_pk_bf16_f32 v82, v77, -v78
    v_cvt_pk_bf16_f32 v98, v78, v77
    v_cos_f32 v77, v75
    v_sin_f32 v78, v75
    v_mul_f32 v76, 0x3d000000, v75
    v_cos_f32 v131, v76
    v_sin_f32 v147, v76
    v_add_f32 v75, v75, v79
    v_cvt_pk_bf16_f32 v83, v77, -v78
    v_cvt_pk_bf16_f32 v99, v78, v77
    v_cos_f32 v77, v75
    v_sin_f32 v78, v75
    v_mul_f32 v76, 0x3d000000, v75
    v_cos_f32 v132, v76
    v_sin_f32 v148, v76
    v_add_f32 v75, v75, v74
    v_cvt_pk_bf16_f32 v84, v77, -v78
    v_cvt_pk_bf16_f32 v100, v78, v77
    v_cos_f32 v77, v75
    v_sin_f32 v78, v75
    v_mul_f32 v76, 0x3d000000, v75
    v_cos_f32 v133, v76
    v_sin_f32 v149, v76
    v_add_f32 v75, v75, v74
    v_cvt_pk_bf16_f32 v85, v77, -v78
    v_cvt_pk_bf16_f32 v101, v78, v77
    v_cos_f32 v77, v75
    v_sin_f32 v78, v75
    v_mul_f32 v76, 0x3d000000, v75
    v_cos_f32 v134, v76
    v_sin_f32 v150, v76
    v_add_f32 v75, v75, v74
    v_cvt_pk_bf16_f32 v86, v77, -v78
    v_cvt_pk_bf16_f32 v102, v78, v77
    v_cos_f32 v77, v75
    v_sin_f32 v78, v75
    v_mul_f32 v76, 0x3d000000, v75
    v_cos_f32 v135, v76
    v_sin_f32 v151, v76
    v_add_f32 v75, v75, v79
    v_cvt_pk_bf16_f32 v87, v77, -v78
    v_cvt_pk_bf16_f32 v103, v78, v77
    v_cos_f32 v77, v75
    v_sin_f32 v78, v75
    v_mul_f32 v76, 0x3d000000, v75
    v_cos_f32 v136, v76
    v_sin_f32 v152, v76
    v_add_f32 v75, v75, v74
    v_cvt_pk_bf16_f32 v88, v77, -v78
    v_cvt_pk_bf16_f32 v104, v78, v77
    v_cvt_pk_bf16_f32 v112, v77, v78
    v_cvt_pk_bf16_f32 v120, v78, -v77
    v_cos_f32 v77, v75
    v_sin_f32 v78, v75
    v_mul_f32 v76, 0x3d000000, v75
    v_cos_f32 v137, v76
    v_sin_f32 v153, v76
    v_add_f32 v75, v75, v74
    v_cvt_pk_bf16_f32 v89, v77, -v78
    v_cvt_pk_bf16_f32 v105, v78, v77
    v_cvt_pk_bf16_f32 v113, v77, v78
    v_cvt_pk_bf16_f32 v121, v78, -v77
    v_cos_f32 v77, v75
    v_sin_f32 v78, v75
    v_mul_f32 v76, 0x3d000000, v75
    v_cos_f32 v138, v76
    v_sin_f32 v154, v76
    v_add_f32 v75, v75, v74
    v_cvt_pk_bf16_f32 v90, v77, -v78
    v_cvt_pk_bf16_f32 v106, v78, v77
    v_cvt_pk_bf16_f32 v114, v77, v78
    v_cvt_pk_bf16_f32 v122, v78, -v77
    v_cos_f32 v77, v75
    v_sin_f32 v78, v75
    v_mul_f32 v76, 0x3d000000, v75
    v_cos_f32 v139, v76
    v_sin_f32 v155, v76
    v_add_f32 v75, v75, v79
    v_cvt_pk_bf16_f32 v91, v77, -v78
    v_cvt_pk_bf16_f32 v107, v78, v77
    v_cvt_pk_bf16_f32 v115, v77, v78
    v_cvt_pk_bf16_f32 v123, v78, -v77
    v_cos_f32 v77, v75
    v_sin_f32 v78, v75
    v_mul_f32 v76, 0x3d000000, v75
    v_cos_f32 v140, v76
    v_sin_f32 v156, v76
    v_add_f32 v75, v75, v74
    v_cvt_pk_bf16_f32 v92, v77, -v78
    v_cvt_pk_bf16_f32 v108, v78, v77
    v_cvt_pk_bf16_f32 v116, v77, v78
    v_cvt_pk_bf16_f32 v124, v78, -v77
    v_cos_f32 v77, v75
    v_sin_f32 v78, v75
    v_mul_f32 v76, 0x3d000000, v75
    v_cos_f32 v141, v76
    v_sin_f32 v157, v76
    v_add_f32 v75, v75, v74
    v_cvt_pk_bf16_f32 v93, v77, -v78
    v_cvt_pk_bf16_f32 v109, v78, v77
    v_cvt_pk_bf16_f32 v117, v77, v78
    v_cvt_pk_bf16_f32 v125, v78, -v77
    v_cos_f32 v77, v75
    v_sin_f32 v78, v75
    v_mul_f32 v76, 0x3d000000, v75
    v_cos_f32 v142, v76
    v_sin_f32 v158, v76
    v_add_f32 v75, v75, v74
    v_cvt_pk_bf16_f32 v94, v77, -v78
    v_cvt_pk_bf16_f32 v110, v78, v77
    v_cvt_pk_bf16_f32 v118, v77, v78
    v_cvt_pk_bf16_f32 v126, v78, -v77
    v_cos_f32 v77, v75
    v_sin_f32 v78, v75
    v_mul_f32 v76, 0x3d000000, v75
    v_cos_f32 v143, v76
    v_sin_f32 v159, v76
    v_cvt_pk_bf16_f32 v95, v77, -v78
    v_cvt_pk_bf16_f32 v111, v78, v77
    v_cvt_pk_bf16_f32 v119, v77, v78
    v_cvt_pk_bf16_f32 v127, v78, -v77
    v_and_b32 v64, 15, v2
    v_lshrrev_b32 v65, 4, v2
    v_and_b32 v66, 3, v2
    v_lshrrev_b32 v64, 2, v64
    v_cmp_eq_u32 vcc, v64, v65
    s_nop 1
    v_cndmask_b32 v67, 0, -1, vcc
    v_add_u32 v73, 0, v66
    v_cvt_f32_u32 v73, v73
    v_mul_f32 v73, 0x3e000000, v73
    v_mul_f32 v70, 0x00000000, v73
    v_cos_f32 v71, v70
    v_mul_f32 v70, 0x40800000, v73
    v_cos_f32 v72, v70
    s_nop 0
    v_cvt_pk_bf16_f32 v8, v71, v72
    v_and_b32 v8, v67, v8
    v_mul_f32 v70, 0x3f800000, v73
    v_cos_f32 v71, v70
    v_mul_f32 v70, 0x3f800000, v73
    v_add_f32 v70, 0x3e800000, v70
    v_cos_f32 v72, v70
    s_nop 0
    v_cvt_pk_bf16_f32 v9, v71, v72
    v_and_b32 v9, v67, v9
    v_mul_f32 v70, 0x40000000, v73
    v_cos_f32 v71, v70
    v_mul_f32 v70, 0x40000000, v73
    v_add_f32 v70, 0x3e800000, v70
    v_cos_f32 v72, v70
    s_nop 0
    v_cvt_pk_bf16_f32 v10, v71, v72
    v_and_b32 v10, v67, v10
    v_mul_f32 v70, 0x40400000, v73
    v_cos_f32 v71, v70
    v_mul_f32 v70, 0x40400000, v73
    v_add_f32 v70, 0x3e800000, v70
    v_cos_f32 v72, v70
    s_nop 0
    v_cvt_pk_bf16_f32 v11, v71, v72
    v_and_b32 v11, v67, v11
    v_add_u32 v73, 4, v66
    v_cvt_f32_u32 v73, v73
    v_mul_f32 v73, 0x3e000000, v73
    v_mul_f32 v70, 0x00000000, v73
    v_cos_f32 v71, v70
    v_mul_f32 v70, 0x40800000, v73
    v_cos_f32 v72, v70
    s_nop 0
    v_cvt_pk_bf16_f32 v12, v71, v72
    v_and_b32 v12, v67, v12
    v_mul_f32 v70, 0x3f800000, v73
    v_cos_f32 v71, v70
    v_mul_f32 v70, 0x3f800000, v73
    v_add_f32 v70, 0x3e800000, v70
    v_cos_f32 v72, v70
    s_nop 0
    v_cvt_pk_bf16_f32 v13, v71, v72
    v_and_b32 v13, v67, v13
    v_mul_f32 v70, 0x40000000, v73
    v_cos_f32 v71, v70
    v_mul_f32 v70, 0x40000000, v73
    v_add_f32 v70, 0x3e800000, v70
    v_cos_f32 v72, v70
    s_nop 0
    v_cvt_pk_bf16_f32 v14, v71, v72
    v_and_b32 v14, v67, v14
    v_mul_f32 v70, 0x40400000, v73
    v_cos_f32 v71, v70
    v_mul_f32 v70, 0x40400000, v73
    v_add_f32 v70, 0x3e800000, v70
    v_cos_f32 v72, v70
    s_nop 0
    v_cvt_pk_bf16_f32 v15, v71, v72
    v_and_b32 v15, v67, v15
    v_and_b32 v6, 31, v2
    v_lshlrev_b32 v6, 2, v6
    v_lshrrev_b32 v7, 5, v2
    v_lshl_add_u32 v6, v7, 9, v6
    s_lshl_b32 s4, s8, 12
    s_cmp_eq_u32 s8, 4
    s_cselect_b32 s4, 2, s4
    v_add_u32 v6, s4, v6
    s_lshl_b32 s10, s8, 12
    s_cmp_eq_u32 s8, 4
    s_cselect_b32 s10, 2048, s10
    s_add_u32 s10, s10, 0
    s_lshl_b32 s4, s2, 14
    s_lshl_b32 s11, s8, 11
    s_add_u32 s11, s11, s4
    s_lshl_b32 s12, s9, 11
    s_add_u32 s12, s12, s4
    v_lshlrev_b32 v3, 4, v2
    s_lshr_b32 s4, s2, 2
    v_and_b32 v64, 31, v2
    v_lshrrev_b32 v65, 5, v2
    v_bfe_u32 v66, v64, 2, 2
    v_add_u32 v66, s4, v66
    v_and_b32 v66, 3, v66
    v_lshlrev_b32 v66, 4, v66
    v_and_b32 v67, 3, v64
    v_lshl_add_u32 v66, v67, 2, v66
    v_lshrrev_b32 v67, 4, v64
    v_lshl_add_u32 v66, v67, 6, v66
    v_lshl_add_u32 v66, v65, 9, v66
    v_add_u32 v164, s10, v66
    v_and_b32 v64, 31, v2
    v_lshrrev_b32 v65, 5, v2
    v_sub_u32 v64, 31, v64
    v_sub_u32 v65, 1, v65
    v_bfe_u32 v66, v64, 2, 2
    v_add_u32 v66, s4, v66
    v_and_b32 v66, 3, v66
    v_lshlrev_b32 v66, 4, v66
    v_and_b32 v67, 3, v64
    v_lshl_add_u32 v66, v67, 2, v66
    v_lshrrev_b32 v67, 4, v64
    v_lshl_add_u32 v66, v67, 6, v66
    v_lshl_add_u32 v66, v65, 9, v66
    v_add_u32 v165, s10, v66
    v_add_u32 v165, 2048, v165
    s_cmp_eq_u32 s3, 4
    s_cbranch_scc0 .b3_wait
    s_setprio 2
    s_branch .wsum
.wsum_ret_b:
    s_setprio 2
    v_mov_b32 v4, 34884
.spin_16:
    ds_read_b32 v5, v4
    s_waitcnt lgkmcnt(0)
    v_readfirstlane_b32 s4, v5
    s_nop 1
    s_cmp_ge_u32 s4, 1
    s_cbranch_scc1 .spun_17
    s_sleep 2
    s_branch .spin_16
.spun_17:
    s_branch .b3_wait2
.b3_wait:
    v_mov_b32 v4, 34884
    v_mov_b32 v5, 1
    s_waitcnt lgkmcnt(0)
    s_mov_b64 exec, 1
    ds_add_u32 v4, v5
    s_mov_b64 exec, -1
.b3_wait2:
    v_lshlrev_b32 v3, 4, v2
    s_mov_b32 s44, s40
    s_and_b32 s45, s41, 0xffff
    s_mov_b32 s46, 0x400000
    s_mov_b32 s47, 0x00020000
    s_mov_b32 s48, s36
    s_and_b32 s49, s37, 0xffff
    s_mov_b32 s50, 0x800000
    s_mov_b32 s51, 0x00020000
    v_mov_b32 v4, 34828
.spin_18:
    ds_read_b32 v5, v4
    s_waitcnt lgkmcnt(0)
    v_readfirstlane_b32 s4, v5
    s_nop 1
    s_cmp_ge_u32 s4, 4
    s_cbranch_scc1 .spun_19
    s_sleep 1
    s_branch .spin_18
.spun_19:
    s_setprio 2
    v_add_u32 v7, s10, v3
    s_mov_b64 s[64:65], -1
    s_mov_b64 s[66:67], -1
    s_cmp_eq_u32 s15, 0
    s_cselect_b64 s[68:69], 0, -1
    s_cselect_b64 s[70:71], 0, -1
    s_mov_b32 s6, 524288
.b3_poll:
    s_mov_b64 exec, s[64:65]
    buffer_load_dwordx4 v[32:35], v3, s[44:47], s11 offen offset:0 sc1
    s_mov_b64 exec, s[66:67]
    buffer_load_dwordx4 v[36:39], v3, s[44:47], s11 offen offset:1024 sc1
    s_mov_b64 exec, s[68:69]
    buffer_load_dwordx4 v[40:43], v3, s[44:47], s12 offen offset:0 sc1
    s_mov_b64 exec, s[70:71]
    buffer_load_dwordx4 v[44:47], v3, s[44:47], s12 offen offset:1024 sc1
    s_mov_b64 exec, s[64:65]
    s_waitcnt vmcnt(0)
    v_and_b32 v4, v32, v34
    v_and_b32 v4, 1, v4
    ds_write_b128 v7, v[32:35] offset:0
    v_cmp_eq_u32 s[64:65], 0, v4
    s_mov_b64 exec, s[66:67]
    v_and_b32 v4, v36, v38
    v_and_b32 v4, 1, v4
    ds_write_b128 v7, v[36:39] offset:1024
    v_cmp_eq_u32 s[66:67], 0, v4
    s_mov_b64 exec, s[68:69]
    v_and_b32 v4, v40, v42
    v_and_b32 v4, 1, v4
    ds_write_b128 v7, v[40:43] offset:2048
    v_cmp_eq_u32 s[68:69], 0, v4
    s_mov_b64 exec, s[70:71]
    v_and_b32 v4, v44, v46
    v_and_b32 v4, 1, v4
    ds_write_b128 v7, v[44:47] offset:3072
    v_cmp_eq_u32 s[70:71], 0, v4
    s_or_b64 s[4:5], s[64:65], s[66:67]
    s_nop 0
    s_or_b64 vcc, s[68:69], s[70:71]
    s_or_b64 s[4:5], s[4:5], vcc
    s_cbranch_scc0 .b3_got
    s_sub_u32 s6, s6, 1
    s_cmp_lg_u32 s6, 0
    s_cbranch_scc1 .b3_poll
.b3_got:
    s_mov_b64 exec, -1
    ds_read_b32 v16, v164 offset:0
    ds_read_b32 v17, v164 offset:128
    ds_read_b32 v18, v164 offset:256
    ds_read_b32 v19, v164 offset:384
    ds_read_b32 v20, v164 offset:1024
    ds_read_b32 v21, v164 offset:1152
    ds_read_b32 v22, v164 offset:1280
    ds_read_b32 v23, v164 offset:1408
    ds_read_b32 v24, v165 offset:1408
    ds_read_b32 v25, v165 offset:1280
    ds_read_b32 v26, v165 offset:1152
    ds_read_b32 v27, v165 offset:1024
    ds_read_b32 v28, v165 offset:384
    ds_read_b32 v29, v165 offset:256
    ds_read_b32 v30, v165 offset:128
    ds_read_b32 v31, v165 offset:0
    s_waitcnt lgkmcnt(0)
    s_cmp_eq_u32 s15, 0
    s_cbranch_scc0 .b3_cplx1
    v_mov_b32 v24, 0
    v_mov_b32 v25, 0
    v_mov_b32 v26, 0
    v_mov_b32 v27, 0
    v_mov_b32 v28, 0
    v_mov_b32 v29, 0
    v_mov_b32 v30, 0
    v_mov_b32 v31, 0
    s_mov_b64 exec, 1
    v_lshrrev_b32 v24, 16, v16
    s_mov_b64 exec, -1
    v_mov_b32 v4, 34880
    v_mov_b32 v5, 1
    s_waitcnt lgkmcnt(0)
    s_mov_b64 exec, 1
    ds_add_u32 v4, v5
    s_mov_b64 exec, -1
.b3_cplx1:
    v_mfma_f32_32x32x16_bf16 v[32:47], v[16:19], v[80:83], 0
    v_mfma_f32_32x32x16_bf16 v[48:63], v[16:19], v[96:99], 0
    v_mfma_f32_32x32x16_bf16 v[32:47], v[20:23], v[84:87], v[32:47]
    v_mfma_f32_32x32x16_bf16 v[48:63], v[20:23], v[100:103], v[48:63]
    v_mfma_f32_32x32x16_bf16 v[32:47], v[24:27], v[112:115], v[32:47]
    v_mfma_f32_32x32x16_bf16 v[48:63], v[24:27], v[120:123], v[48:63]
    v_mfma_f32_32x32x16_bf16 v[32:47], v[28:31], v[116:119], v[32:47]
    v_mfma_f32_32x32x16_bf16 v[48:63], v[28:31], v[124:127], v[48:63]
    s_nop 11
    v_pk_mul_f32 v[64:65], v[48:49], v[144:145]
    v_pk_mul_f32 v[66:67], v[32:33], v[144:145]
    v_pk_mul_f32 v[68:69], v[50:51], v[146:147]
    v_pk_mul_f32 v[70:71], v[34:35], v[146:147]
    v_pk_fma_f32 v[64:65], v[32:33], v[128:129], v[64:65] neg_lo:[0,0,1] neg_hi:[0,0,1]
    v_pk_fma_f32 v[66:67], v[48:49], v[128:129], v[66:67]
    v_pk_fma_f32 v[68:69], v[34:35], v[130:131], v[68:69] neg_lo:[0,0,1] neg_hi:[0,0,1]
    v_pk_fma_f32 v[70:71], v[50:51], v[130:131], v[70:71]
    v_cvt_pk_bf16_f32 v16, v64, v66
    v_cvt_pk_bf16_f32 v17, v65, v67
    v_cvt_pk_bf16_f32 v18, v68, v70
    v_cvt_pk_bf16_f32 v19, v69, v71
    v_pk_mul_f32 v[72:73], v[52:53], v[148:149]
    v_pk_mul_f32 v[74:75], v[36:37], v[148:149]
    v_pk_mul_f32 v[76:77], v[54:55], v[150:151]
    v_pk_mul_f32 v[78:79], v[38:39], v[150:151]
    v_pk_fma_f32 v[72:73], v[36:37], v[132:133], v[72:73] neg_lo:[0,0,1] neg_hi:[0,0,1]
    v_pk_fma_f32 v[74:75], v[52:53], v[132:133], v[74:75]
    v_pk_fma_f32 v[76:77], v[38:39], v[134:135], v[76:77] neg_lo:[0,0,1] neg_hi:[0,0,1]
    v_pk_fma_f32 v[78:79], v[54:55], v[134:135], v[78:79]
    v_cvt_pk_bf16_f32 v20, v72, v74
    v_cvt_pk_bf16_f32 v21, v73, v75
    v_cvt_pk_bf16_f32 v22, v76, v78
    v_cvt_pk_bf16_f32 v23, v77, v79
    v_pk_mul_f32 v[64:65], v[56:57], v[152:153]
    v_pk_mul_f32 v[66:67], v[40:41], v[152:153]
    v_pk_mul_f32 v[68:69], v[58:59], v[154:155]
    v_pk_mul_f32 v[70:71], v[42:43], v[154:155]
    v_pk_fma_f32 v[64:65], v[40:41], v[136:137], v[64:65] neg_lo:[0,0,1] neg_hi:[0,0,1]
    v_pk_fma_f32 v[66:67], v[56:57], v[136:137], v[66:67]
    v_pk_fma_f32 v[68:69], v[42:43], v[138:139], v[68:69] neg_lo:[0,0,1] neg_hi:[0,0,1]
    v_pk_fma_f32 v[70:71], v[58:59], v[138:139], v[70:71]
    v_cvt_pk_bf16_f32 v24, v64, v66
    v_cvt_pk_bf16_f32 v25, v65, v67
    v_cvt_pk_bf16_f32 v26, v68, v70
    v_cvt_pk_bf16_f32 v27, v69, v71
    v_pk_mul_f32 v[72:73], v[60:61], v[156:157]
    v_pk_mul_f32 v[74:75], v[44:45], v[156:157]
    v_pk_mul_f32 v[76:77], v[62:63], v[158:159]
    v_pk_mul_f32 v[78:79], v[46:47], v[158:159]
    v_pk_fma_f32 v[72:73], v[44:45], v[140:141], v[72:73] neg_lo:[0,0,1] neg_hi:[0,0,1]
    v_pk_fma_f32 v[74:75], v[60:61], v[140:141], v[74:75]
    v_pk_fma_f32 v[76:77], v[46:47], v[142:143], v[76:77] neg_lo:[0,0,1] neg_hi:[0,0,1]
    v_pk_fma_f32 v[78:79], v[62:63], v[142:143], v[78:79]
    v_cvt_pk_bf16_f32 v28, v72, v74
    v_cvt_pk_bf16_f32 v29, v73, v75
    v_cvt_pk_bf16_f32 v30, v76, v78
    v_cvt_pk_bf16_f32 v31, v77, v79
    v_mfma_f32_32x32x16_bf16 v[32:47], v[80:83], v[16:19], 0
    v_mfma_f32_32x32x16_bf16 v[32:47], v[84:87], v[20:23], v[32:47]
    v_mfma_f32_32x32x16_bf16 v[32:47], v[88:91], v[24:27], v[32:47]
    v_mfma_f32_32x32x16_bf16 v[32:47], v[92:95], v[28:31], v[32:47]
    s_cmp_eq_u32 s15, 0
    s_cbranch_scc1 .b3_real2
    v_mfma_f32_32x32x16_bf16 v[48:63], v[96:99], v[16:19], 0
    v_mfma_f32_32x32x16_bf16 v[48:63], v[100:103], v[20:23], v[48:63]
    v_mfma_f32_32x32x16_bf16 v[48:63], v[104:107], v[24:27], v[48:63]
    v_mfma_f32_32x32x16_bf16 v[48:63], v[108:111], v[28:31], v[48:63]
    s_nop 11
    v_cvt_pk_bf16_f32 v64, v32, v48
    ds_write_b32 v6, v64 offset:0
    v_cvt_pk_bf16_f32 v65, v33, v49
    ds_write_b32 v6, v65 offset:128
    v_cvt_pk_bf16_f32 v66, v34, v50
    ds_write_b32 v6, v66 offset:256
    v_cvt_pk_bf16_f32 v67, v35, v51
    ds_write_b32 v6, v67 offset:384
    v_cvt_pk_bf16_f32 v68, v36, v52
    ds_write_b32 v6, v68 offset:1024
    v_cvt_pk_bf16_f32 v69, v37, v53
    ds_write_b32 v6, v69 offset:1152
    v_cvt_pk_bf16_f32 v70, v38, v54
    ds_write_b32 v6, v70 offset:1280
    v_cvt_pk_bf16_f32 v71, v39, v55
    ds_write_b32 v6, v71 offset:1408
    v_cvt_pk_bf16_f32 v72, v40, v56
    ds_write_b32 v6, v72 offset:2048
    v_cvt_pk_bf16_f32 v73, v41, v57
    ds_write_b32 v6, v73 offset:2176
    v_cvt_pk_bf16_f32 v74, v42, v58
    ds_write_b32 v6, v74 offset:2304
    v_cvt_pk_bf16_f32 v75, v43, v59
    ds_write_b32 v6, v75 offset:2432
    v_cvt_pk_bf16_f32 v76, v44, v60
    ds_write_b32 v6, v76 offset:3072
    v_cvt_pk_bf16_f32 v77, v45, v61
    ds_write_b32 v6, v77 offset:3200
    v_cvt_pk_bf16_f32 v78, v46, v62
    ds_write_b32 v6, v78 offset:3328
    v_cvt_pk_bf16_f32 v79, v47, v63
    ds_write_b32 v6, v79 offset:3456
    s_branch .b3_join
.b3_real2:
    v_mov_b32 v4, 34880
.spin_20:
    ds_read_b32 v5, v4
    s_waitcnt lgkmcnt(0)
    v_readfirstlane_b32 s4, v5
    s_nop 1
    s_cmp_ge_u32 s4, 2
    s_cbranch_scc1 .spun_21
    s_sleep 0
    s_branch .spin_20
.spun_21:
    s_nop 1
    v_cvt_pk_bf16_f32 v64, v32, v33
    ds_write_b16 v6, v64 offset:0
    ds_write_b16_d16_hi v6, v64 offset:128
    v_cvt_pk_bf16_f32 v65, v34, v35
    ds_write_b16 v6, v65 offset:256
    ds_write_b16_d16_hi v6, v65 offset:384
    v_cvt_pk_bf16_f32 v66, v36, v37
    ds_write_b16 v6, v66 offset:1024
    ds_write_b16_d16_hi v6, v66 offset:1152
    v_cvt_pk_bf16_f32 v67, v38, v39
    ds_write_b16 v6, v67 offset:1280
    ds_write_b16_d16_hi v6, v67 offset:1408
    v_cvt_pk_bf16_f32 v68, v40, v41
    ds_write_b16 v6, v68 offset:2048
    ds_write_b16_d16_hi v6, v68 offset:2176
    v_cvt_pk_bf16_f32 v69, v42, v43
    ds_write_b16 v6, v69 offset:2304
    ds_write_b16_d16_hi v6, v69 offset:2432
    v_cvt_pk_bf16_f32 v70, v44, v45
    ds_write_b16 v6, v70 offset:3072
    ds_write_b16_d16_hi v6, v70 offset:3200
    v_cvt_pk_bf16_f32 v71, v46, v47
    ds_write_b16 v6, v71 offset:3328
    ds_write_b16_d16_hi v6, v71 offset:3456
.b3_join:
    v_mov_b32 v4, 34848
    v_mov_b32 v5, 1
    s_waitcnt lgkmcnt(0)
    s_mov_b64 exec, 1
    ds_add_u32 v4, v5
    s_mov_b64 exec, -1
    s_cmp_eq_u32 s3, 4
    s_cbranch_scc1 .b3_end
    v_mov_b32 v4, 34848
.spin_22:
    ds_read_b32 v5, v4
    s_waitcnt lgkmcnt(0)
    v_readfirstlane_b32 s4, v5
    s_nop 1
    s_cmp_ge_u32 s4, 5
    s_cbranch_scc1 .spun_23
    s_sleep 0
    s_branch .spin_22
.spun_23:
    v_lshlrev_b32 v6, 4, v0
    ds_read_b128 v[64:67], v6 offset:0
    ds_read_b128 v[68:71], v6 offset:4096
    ds_read_b128 v[72:75], v6 offset:8192
    ds_read_b128 v[76:79], v6 offset:12288
    s_lshl_b32 s4, s2, 12
    s_add_u32 s4, s4, 2048
    v_lshlrev_b32 v7, 3, v0
    v_add_u32 v7, s4, v7
    s_waitcnt lgkmcnt(3)
    v_mov_b32 v16, v64
    v_mov_b32 v20, v65
    v_mov_b32 v24, v66
    v_mov_b32 v28, v67
    s_waitcnt lgkmcnt(2)
    v_mov_b32 v17, v68
    v_mov_b32 v21, v69
    v_mov_b32 v25, v70
    v_mov_b32 v29, v71
    s_waitcnt lgkmcnt(1)
    v_mov_b32 v18, v72
    v_mov_b32 v22, v73
    v_mov_b32 v26, v74
    v_mov_b32 v30, v75
    s_waitcnt lgkmcnt(0)
    v_mov_b32 v19, v76
    v_mov_b32 v23, v77
    v_mov_b32 v27, v78
    v_mov_b32 v31, v79
    v_mfma_f32_16x16x32_bf16 v[32:35], v[8:11], v[16:19], 0
    v_mfma_f32_16x16x32_bf16 v[36:39], v[12:15], v[16:19], 0
    v_mfma_f32_16x16x32_bf16 v[40:43], v[8:11], v[20:23], 0
    v_mfma_f32_16x16x32_bf16 v[44:47], v[12:15], v[20:23], 0
    v_mfma_f32_16x16x32_bf16 v[48:51], v[8:11], v[24:27], 0
    v_mfma_f32_16x16x32_bf16 v[52:55], v[12:15], v[24:27], 0
    v_mfma_f32_16x16x32_bf16 v[56:59], v[8:11], v[28:31], 0
    v_mfma_f32_16x16x32_bf16 v[60:63], v[12:15], v[28:31], 0
    s_nop 2
    v_cvt_pk_bf16_f32 v64, v32, v40
    s_nop 2
    v_cvt_pk_bf16_f32 v65, v48, v56
    s_mov_b32 s5, 0
    buffer_store_dwordx2 v[64:65], v7, s[48:51], s5 offen sc1
    v_cvt_pk_bf16_f32 v66, v33, v41
    v_cvt_pk_bf16_f32 v67, v49, v57
    s_mov_b32 s5, 1048576
    buffer_store_dwordx2 v[66:67], v7, s[48:51], s5 offen sc1
    v_cvt_pk_bf16_f32 v68, v34, v42
    v_cvt_pk_bf16_f32 v69, v50, v58
    s_mov_b32 s5, 2097152
    buffer_store_dwordx2 v[68:69], v7, s[48:51], s5 offen sc1
    v_cvt_pk_bf16_f32 v70, v35, v43
    v_cvt_pk_bf16_f32 v71, v51, v59
    s_mov_b32 s5, 3145728
    buffer_store_dwordx2 v[70:71], v7, s[48:51], s5 offen sc1
    v_cvt_pk_bf16_f32 v72, v36, v44
    v_cvt_pk_bf16_f32 v73, v52, v60
    s_mov_b32 s5, 4194304
    buffer_store_dwordx2 v[72:73], v7, s[48:51], s5 offen sc1
    v_cvt_pk_bf16_f32 v74, v37, v45
    v_cvt_pk_bf16_f32 v75, v53, v61
    s_mov_b32 s5, 5242880
    buffer_store_dwordx2 v[74:75], v7, s[48:51], s5 offen sc1
    v_cvt_pk_bf16_f32 v76, v38, v46
    v_cvt_pk_bf16_f32 v77, v54, v62
    s_mov_b32 s5, 6291456
    buffer_store_dwordx2 v[76:77], v7, s[48:51], s5 offen sc1
    v_cvt_pk_bf16_f32 v78, v39, v47
    v_cvt_pk_bf16_f32 v79, v55, v63
    s_mov_b32 s5, 7340032
    buffer_store_dwordx2 v[78:79], v7, s[48:51], s5 offen sc1
.b3_end:
    s_endpgm
.role_t:
    s_setprio 2
    s_sub_u32 s8, s3, 5
    s_and_b32 s9, s2, 15
    s_lshl_b32 s9, s9, 1
    s_add_u32 s9, s9, s8
    s_lshl_b32 s9, s9, 4
    s_lshr_b32 s11, s2, 4
    s_add_u32 s9, s9, s11
    s_mul_i32 s10, s8, 9216
    s_add_u32 s10, s10, 16384
    s_lshl_b32 s14, s2, 4
    s_add_u32 s14, s14, 8192
    s_lshl_b32 s15, s11, 8
    s_add_u32 s15, s15, 8192
    s_waitcnt lgkmcnt(0)
    s_barrier
    s_mov_b32 s44, s16
    s_and_b32 s45, s17, 0xffff
    s_mov_b32 s46, 0x400000
    s_mov_b32 s47, 0x00020000
    s_and_b32 s4, s9, 15
    s_lshr_b32 s5, s9, 4
    s_mul_i32 s6, s5, 131072
    s_lshl_b32 s7, s4, 7
    s_add_u32 s6, s6, s7
    v_lshrrev_b32 v3, 3, v2
    v_and_b32 v4, 7, v2
    v_lshlrev_b32 v4, 4, v4
    v_mul_u32_u24 v5, 2048, v3
    v_add3_u32 v5, v5, v4, s6
    v_mul_u32_u24 v6, 144, v3
    v_add3_u32 v6, v6, v4, s10
    s_mov_b32 s7, 0
    buffer_load_dwordx4 v[16:19], v5, s[44:47], s7 offen
    s_mov_b32 s7, 16384
    buffer_load_dwordx4 v[20:23], v5, s[44:47], s7 offen
    s_mov_b32 s7, 32768
    buffer_load_dwordx4 v[24:27], v5, s[44:47], s7 offen
    s_mov_b32 s7, 49152
    buffer_load_dwordx4 v[28:31], v5, s[44:47], s7 offen
    s_mov_b32 s7, 65536
    buffer_load_dwordx4 v[32:35], v5, s[44:47], s7 offen
    s_mov_b32 s7, 81920
    buffer_load_dwordx4 v[36:39], v5, s[44:47], s7 offen
    s_mov_b32 s7, 98304
    buffer_load_dwordx4 v[40:43], v5, s[44:47], s7 offen
    s_mov_b32 s7, 114688
    buffer_load_dwordx4 v[44:47], v5, s[44:47], s7 offen
    s_mov_b32 s12, s5
    s_mov_b32 s5, s12
    s_add_u32 s48, s40, 0x800000
    s_addc_u32 s49, s41, 0
    s_and_b32 s49, s49, 0xffff
    s_mov_b32 s50, 0x420000
    s_mov_b32 s51, 0x00020000
    v_mov_b32 v10, 34868
.spin_24:
    ds_read_b32 v11, v10
    s_waitcnt lgkmcnt(0)
    v_readfirstlane_b32 s14, v11
    s_nop 1
    s_cmp_ge_u32 s14, 1
    s_cbranch_scc1 .spun_25
    s_sleep 1
    s_branch .spin_24
.spun_25:
    s_and_b32 s14, s14, 0xfcfcfcd8
    s_or_b32 s14, s14, 0x18
    v_lshrrev_b32 v10, 4, v2
    v_lshlrev_b32 v10, 3, v10
    v_lshrrev_b32 v10, v10, s14
    s_mov_b32 s13, 0xfffefffe
    v_bfe_u32 v12, v10, 0, 1
    v_bfe_u32 v11, v10, 2, 1
    v_lshl_or_b32 v12, v11, 16, v12
    v_bfe_u32 v13, v10, 4, 1
    v_bfe_u32 v11, v10, 6, 1
    v_lshl_or_b32 v13, v11, 16, v13
    v_bfe_u32 v14, v10, 1, 1
    v_bfe_u32 v11, v10, 3, 1
    v_lshl_or_b32 v14, v11, 16, v14
    v_bfe_u32 v15, v10, 5, 1
    v_bfe_u32 v11, v10, 7, 1
    v_lshl_or_b32 v15, v11, 16, v15
    v_lshrrev_b32 v7, 4, v2
    v_bfe_u32 v8, v2, 2, 2
    v_lshl_add_u32 v8, v7, 3, v8
    v_mul_u32_u24 v8, 144, v8
    v_and_b32 v9, 1, v2
    v_lshl_add_u32 v8, v9, 3, v8
    v_bfe_u32 v9, v2, 1, 1
    v_mul_u32_u24 v9, 4624, v9
    v_add3_u32 v8, v8, v9, s10
    s_mul_i32 s6, s4, 270336
    s_lshl_b32 s7, s5, 7
    s_add_u32 s6, s6, s7
    s_add_u32 s6, s6, 0
    v_and_b32 v9, 7, v2
    v_mul_u32_u24 v9, 4224, v9
    v_lshl_add_u32 v9, v7, 4, v9
    v_bfe_u32 v7, v2, 3, 1
    v_lshl_add_u32 v9, v7, 6, v9
    v_add_u32 v9, s6, v9
    s_waitcnt vmcnt(7)
    ds_write_b128 v6, v[16:19] offset:0
    s_waitcnt vmcnt(6)
    ds_write_b128 v6, v[20:23] offset:1152
    s_waitcnt vmcnt(5)
    ds_write_b128 v6, v[24:27] offset:2304
    s_waitcnt vmcnt(4)
    ds_write_b128 v6, v[28:31] offset:3456
    s_waitcnt vmcnt(3)
    ds_write_b128 v6, v[32:35] offset:4624
    s_waitcnt vmcnt(2)
    ds_write_b128 v6, v[36:39] offset:5776
    s_waitcnt vmcnt(1)
    ds_write_b128 v6, v[40:43] offset:6928
    s_waitcnt vmcnt(0)
    ds_write_b128 v6, v[44:47] offset:8080
    s_waitcnt lgkmcnt(0)
    ds_read_b64_tr_b16 v[48:49], v8 offset:0
    ds_read_b64_tr_b16 v[50:51], v8 offset:576
    ds_read_b64_tr_b16 v[52:53], v8 offset:16
    ds_read_b64_tr_b16 v[54:55], v8 offset:592
    ds_read_b64_tr_b16 v[56:57], v8 offset:32
    ds_read_b64_tr_b16 v[58:59], v8 offset:608
    ds_read_b64_tr_b16 v[60:61], v8 offset:48
    ds_read_b64_tr_b16 v[62:63], v8 offset:624
    ds_read_b64_tr_b16 v[64:65], v8 offset:64
    ds_read_b64_tr_b16 v[66:67], v8 offset:640
    ds_read_b64_tr_b16 v[68:69], v8 offset:80
    ds_read_b64_tr_b16 v[70:71], v8 offset:656
    ds_read_b64_tr_b16 v[72:73], v8 offset:96
    ds_read_b64_tr_b16 v[74:75], v8 offset:672
    ds_read_b64_tr_b16 v[76:77], v8 offset:112
    ds_read_b64_tr_b16 v[78:79], v8 offset:688
    s_waitcnt lgkmcnt(14)
    s_mov_b32 s7, 0
    v_and_or_b32 v48, v48, s13, v12
    v_and_or_b32 v49, v49, s13, v13
    v_and_or_b32 v50, v50, s13, v14
    v_and_or_b32 v51, v51, s13, v15
    buffer_store_dwordx4 v[48:51], v9, s[48:51], s7 offen sc1
    s_waitcnt lgkmcnt(12)
    s_mov_b32 s7, 33792
    v_and_or_b32 v52, v52, s13, v12
    v_and_or_b32 v53, v53, s13, v13
    v_and_or_b32 v54, v54, s13, v14
    v_and_or_b32 v55, v55, s13, v15
    buffer_store_dwordx4 v[52:55], v9, s[48:51], s7 offen sc1
    s_waitcnt lgkmcnt(10)
    s_mov_b32 s7, 67584
    v_and_or_b32 v56, v56, s13, v12
    v_and_or_b32 v57, v57, s13, v13
    v_and_or_b32 v58, v58, s13, v14
    v_and_or_b32 v59, v59, s13, v15
    buffer_store_dwordx4 v[56:59], v9, s[48:51], s7 offen sc1
    s_waitcnt lgkmcnt(8)
    s_mov_b32 s7, 101376
    v_and_or_b32 v60, v60, s13, v12
    v_and_or_b32 v61, v61, s13, v13
    v_and_or_b32 v62, v62, s13, v14
    v_and_or_b32 v63, v63, s13, v15
    buffer_store_dwordx4 v[60:63], v9, s[48:51], s7 offen sc1
    s_waitcnt lgkmcnt(6)
    s_mov_b32 s7, 135168
    v_and_or_b32 v64, v64, s13, v12
    v_and_or_b32 v65, v65, s13, v13
    v_and_or_b32 v66, v66, s13, v14
    v_and_or_b32 v67, v67, s13, v15
    buffer_store_dwordx4 v[64:67], v9, s[48:51], s7 offen sc1
    s_waitcnt lgkmcnt(4)
    s_mov_b32 s7, 168960
    v_and_or_b32 v68, v68, s13, v12
    v_and_or_b32 v69, v69, s13, v13
    v_and_or_b32 v70, v70, s13, v14
    v_and_or_b32 v71, v71, s13, v15
    buffer_store_dwordx4 v[68:71], v9, s[48:51], s7 offen sc1
    s_waitcnt lgkmcnt(2)
    s_mov_b32 s7, 202752
    v_and_or_b32 v72, v72, s13, v12
    v_and_or_b32 v73, v73, s13, v13
    v_and_or_b32 v74, v74, s13, v14
    v_and_or_b32 v75, v75, s13, v15
    buffer_store_dwordx4 v[72:75], v9, s[48:51], s7 offen sc1
    s_waitcnt lgkmcnt(0)
    s_mov_b32 s7, 236544
    v_and_or_b32 v76, v76, s13, v12
    v_and_or_b32 v77, v77, s13, v13
    v_and_or_b32 v78, v78, s13, v14
    v_and_or_b32 v79, v79, s13, v15
    buffer_store_dwordx4 v[76:79], v9, s[48:51], s7 offen sc1
    v_mov_b32 v10, 34876
    v_mov_b32 v11, 1
    s_waitcnt lgkmcnt(0)
    s_mov_b64 exec, 1
    ds_add_u32 v10, v11
    s_mov_b64 exec, -1
    s_waitcnt vmcnt(0)
    v_mov_b32 v10, 34852
    v_mov_b32 v11, 1
    s_waitcnt lgkmcnt(0)
    s_mov_b64 exec, 1
    ds_add_u32 v10, v11
    s_mov_b64 exec, -1
    s_branch .wsum
.wsum_ret_t:
    s_setprio 2
    s_cmp_eq_u32 s8, 0
    s_cbranch_scc0 .t_second
    s_branch .t_third
.t_second:
    s_cmp_eq_u32 s2, 74
    s_cbranch_scc0 .t_third
    v_mov_b32 v10, 34868
.spin_26:
    ds_read_b32 v11, v10
    s_waitcnt lgkmcnt(0)
    v_readfirstlane_b32 s5, v11
    s_nop 1
    s_cmp_ge_u32 s5, 1
    s_cbranch_scc1 .spun_27
    s_sleep 1
    s_branch .spin_26
.spun_27:
    v_mov_b32 v10, 34832
.spin_28:
    ds_read_b32 v11, v10
    s_waitcnt lgkmcnt(0)
    v_readfirstlane_b32 s4, v11
    s_nop 1
    s_cmp_ge_u32 s4, 4
    s_cbranch_scc1 .spun_29
    s_sleep 4
    s_branch .spin_28
.spun_29:
    s_add_u32 s64, s40, 0x1408000
    s_addc_u32 s65, s41, 0
    s_and_b32 s65, s65, 0xffff
    s_mov_b32 s66, 0x100
    s_mov_b32 s67, 0x00020000
    v_mov_b32 v8, s5
    v_mov_b32 v4, 0
    s_mov_b64 exec, 1
    buffer_store_dword v8, v4, s[64:67], 0 offen sc1
    s_mov_b64 exec, -1
.t_third:
    v_mov_b32 v10, 34860
.spin_30:
    ds_read_b32 v11, v10
    s_waitcnt lgkmcnt(0)
    v_readfirstlane_b32 s4, v11
    s_nop 1
    s_cmp_ge_u32 s4, 4
    s_cbranch_scc1 .spun_31
    s_sleep 2
    s_branch .spin_30
.spun_31:
    v_mov_b32 v10, 34840
.spin_32:
    ds_read_b32 v11, v10
    s_waitcnt lgkmcnt(0)
    v_readfirstlane_b32 s4, v11
    s_nop 1
    s_cmp_ge_u32 s4, 4
    s_cbranch_scc1 .spun_33
    s_sleep 1
    s_branch .spin_32
.spun_33:
    s_add_u32 s44, s40, 0x800000
    s_addc_u32 s45, s41, 0
    s_and_b32 s45, s45, 0xffff
    s_mov_b32 s46, 0x420000
    s_mov_b32 s47, 0x00020000
    s_mov_b32 s48, s36
    s_and_b32 s49, s37, 0xffff
    s_mov_b32 s50, 0x800000
    s_mov_b32 s51, 0x00020000
    s_lshr_b32 s4, s9, 4
    s_and_b32 s5, s9, 15
    s_mul_i32 s6, s5, 270336
    s_lshl_b32 s7, s4, 7
    s_add_u32 s6, s6, s7
    v_lshrrev_b32 v3, 3, v2
    v_and_b32 v4, 7, v2
    v_lshlrev_b32 v4, 4, v4
    v_mul_u32_u24 v5, 4224, v3
    v_add3_u32 v5, v5, v4, s6
    v_mul_u32_u24 v6, 144, v3
    v_add3_u32 v6, v6, v4, s10
    s_mov_b32 s7, 0
    buffer_load_dwordx4 v[16:19], v5, s[44:47], s7 offen sc1
    s_mov_b32 s7, 33792
    buffer_load_dwordx4 v[20:23], v5, s[44:47], s7 offen sc1
    s_mov_b32 s7, 67584
    buffer_load_dwordx4 v[24:27], v5, s[44:47], s7 offen sc1
    s_mov_b32 s7, 101376
    buffer_load_dwordx4 v[28:31], v5, s[44:47], s7 offen sc1
    s_mov_b32 s7, 135168
    buffer_load_dwordx4 v[32:35], v5, s[44:47], s7 offen sc1
    s_mov_b32 s7, 168960
    buffer_load_dwordx4 v[36:39], v5, s[44:47], s7 offen sc1
    s_mov_b32 s7, 202752
    buffer_load_dwordx4 v[40:43], v5, s[44:47], s7 offen sc1
    s_mov_b32 s7, 236544
    buffer_load_dwordx4 v[44:47], v5, s[44:47], s7 offen sc1
    s_mov_b64 s[52:53], -1
    s_mov_b64 s[54:55], -1
    s_mov_b64 s[56:57], -1
    s_mov_b64 s[58:59], -1
    s_mov_b64 s[64:65], -1
    s_mov_b64 s[66:67], -1
    s_mov_b64 s[68:69], -1
    s_mov_b64 s[70:71], -1
    s_mov_b32 s12, 524288
    s_waitcnt vmcnt(0)
.t_poll:
    s_mov_b64 s[60:61], 0
    s_mov_b64 exec, s[52:53]
    v_and_b32 v10, v16, v18
    v_and_b32 v10, 1, v10
    v_cmp_eq_u32 s[52:53], 0, v10
    s_mov_b64 exec, s[54:55]
    v_and_b32 v10, v20, v22
    v_and_b32 v10, 1, v10
    v_cmp_eq_u32 s[54:55], 0, v10
    s_mov_b64 exec, s[56:57]
    v_and_b32 v10, v24, v26
    v_and_b32 v10, 1, v10
    v_cmp_eq_u32 s[56:57], 0, v10
    s_mov_b64 exec, s[58:59]
    v_and_b32 v10, v28, v30
    v_and_b32 v10, 1, v10
    v_cmp_eq_u32 s[58:59], 0, v10
    s_mov_b64 exec, s[64:65]
    v_and_b32 v10, v32, v34
    v_and_b32 v10, 1, v10
    v_cmp_eq_u32 s[64:65], 0, v10
    s_mov_b64 exec, s[66:67]
    v_and_b32 v10, v36, v38
    v_and_b32 v10, 1, v10
    v_cmp_eq_u32 s[66:67], 0, v10
    s_mov_b64 exec, s[68:69]
    v_and_b32 v10, v40, v42
    v_and_b32 v10, 1, v10
    v_cmp_eq_u32 s[68:69], 0, v10
    s_mov_b64 exec, s[70:71]
    v_and_b32 v10, v44, v46
    v_and_b32 v10, 1, v10
    v_cmp_eq_u32 s[70:71], 0, v10
    s_or_b64 s[60:61], s[60:61], s[52:53]
    s_or_b64 s[60:61], s[60:61], s[54:55]
    s_or_b64 s[60:61], s[60:61], s[56:57]
    s_or_b64 s[60:61], s[60:61], s[58:59]
    s_or_b64 s[60:61], s[60:61], s[64:65]
    s_or_b64 s[60:61], s[60:61], s[66:67]
    s_or_b64 s[60:61], s[60:61], s[68:69]
    s_or_b64 s[60:61], s[60:61], s[70:71]
    s_cbranch_scc0 .t_got
    s_sub_u32 s12, s12, 1
    s_cmp_eq_u32 s12, 0
    s_cbranch_scc1 .t_got
    s_mov_b64 exec, s[52:53]
    s_mov_b32 s7, 0
    buffer_load_dwordx4 v[16:19], v5, s[44:47], s7 offen sc1
    s_mov_b64 exec, s[54:55]
    s_mov_b32 s7, 33792
    buffer_load_dwordx4 v[20:23], v5, s[44:47], s7 offen sc1
    s_mov_b64 exec, s[56:57]
    s_mov_b32 s7, 67584
    buffer_load_dwordx4 v[24:27], v5, s[44:47], s7 offen sc1
    s_mov_b64 exec, s[58:59]
    s_mov_b32 s7, 101376
    buffer_load_dwordx4 v[28:31], v5, s[44:47], s7 offen sc1
    s_mov_b64 exec, s[64:65]
    s_mov_b32 s7, 135168
    buffer_load_dwordx4 v[32:35], v5, s[44:47], s7 offen sc1
    s_mov_b64 exec, s[66:67]
    s_mov_b32 s7, 168960
    buffer_load_dwordx4 v[36:39], v5, s[44:47], s7 offen sc1
    s_mov_b64 exec, s[68:69]
    s_mov_b32 s7, 202752
    buffer_load_dwordx4 v[40:43], v5, s[44:47], s7 offen sc1
    s_mov_b64 exec, s[70:71]
    s_mov_b32 s7, 236544
    buffer_load_dwordx4 v[44:47], v5, s[44:47], s7 offen sc1
    s_waitcnt vmcnt(0)
    s_branch .t_poll
.t_got:
    s_mov_b64 exec, -1
    v_lshrrev_b32 v7, 4, v2
    v_bfe_u32 v8, v2, 2, 2
    v_lshl_add_u32 v8, v7, 3, v8
    v_mul_u32_u24 v8, 144, v8
    v_and_b32 v9, 1, v2
    v_lshl_add_u32 v8, v9, 4, v8
    v_bfe_u32 v9, v2, 1, 1
    v_mul_u32_u24 v9, 4624, v9
    v_add3_u32 v8, v8, v9, s10
    s_lshr_b32 s6, s4, 3
    s_lshl_b32 s6, s6, 4
    s_and_b32 s7, s4, 7
    s_add_u32 s6, s6, s7
    s_mul_i32 s6, s6, 131072
    s_lshl_b32 s7, s5, 7
    s_add_u32 s6, s6, s7
    s_add_u32 s6, s6, 0
    v_and_b32 v9, 7, v2
    v_mul_u32_u24 v9, 4096, v9
    v_lshl_add_u32 v9, v7, 4, v9
    v_bfe_u32 v7, v2, 3, 1
    v_lshl_add_u32 v9, v7, 6, v9
    v_add_u32 v9, s6, v9
    ds_write_b128 v6, v[16:19] offset:0
    ds_write_b128 v6, v[20:23] offset:1152
    ds_write_b128 v6, v[24:27] offset:2304
    ds_write_b128 v6, v[28:31] offset:3456
    ds_write_b128 v6, v[32:35] offset:4624
    ds_write_b128 v6, v[36:39] offset:5776
    ds_write_b128 v6, v[40:43] offset:6928
    ds_write_b128 v6, v[44:47] offset:8080
    s_waitcnt lgkmcnt(0)
    ds_read_b64_tr_b16 v[48:49], v8 offset:0
    ds_read_b64_tr_b16 v[50:51], v8 offset:576
    ds_read_b64_tr_b16 v[52:53], v8 offset:32
    ds_read_b64_tr_b16 v[54:55], v8 offset:608
    ds_read_b64_tr_b16 v[56:57], v8 offset:64
    ds_read_b64_tr_b16 v[58:59], v8 offset:640
    ds_read_b64_tr_b16 v[60:61], v8 offset:96
    ds_read_b64_tr_b16 v[62:63], v8 offset:672
    ds_read_b64_tr_b16 v[64:65], v8 offset:8
    ds_read_b64_tr_b16 v[66:67], v8 offset:584
    ds_read_b64_tr_b16 v[68:69], v8 offset:40
    ds_read_b64_tr_b16 v[70:71], v8 offset:616
    ds_read_b64_tr_b16 v[72:73], v8 offset:72
    ds_read_b64_tr_b16 v[74:75], v8 offset:648
    ds_read_b64_tr_b16 v[76:77], v8 offset:104
    ds_read_b64_tr_b16 v[78:79], v8 offset:680
    s_waitcnt lgkmcnt(14)
    s_mov_b32 s7, 0
    buffer_store_dwordx4 v[48:51], v9, s[48:51], s7 offen sc1
    s_waitcnt lgkmcnt(12)
    s_mov_b32 s7, 32768
    buffer_store_dwordx4 v[52:55], v9, s[48:51], s7 offen sc1
    s_waitcnt lgkmcnt(10)
    s_mov_b32 s7, 65536
    buffer_store_dwordx4 v[56:59], v9, s[48:51], s7 offen sc1
    s_waitcnt lgkmcnt(8)
    s_mov_b32 s7, 98304
    buffer_store_dwordx4 v[60:63], v9, s[48:51], s7 offen sc1
    s_waitcnt lgkmcnt(6)
    s_mov_b32 s7, 1048576
    buffer_store_dwordx4 v[64:67], v9, s[48:51], s7 offen sc1
    s_waitcnt lgkmcnt(4)
    s_mov_b32 s7, 1081344
    buffer_store_dwordx4 v[68:71], v9, s[48:51], s7 offen sc1
    s_waitcnt lgkmcnt(2)
    s_mov_b32 s7, 1114112
    buffer_store_dwordx4 v[72:75], v9, s[48:51], s7 offen sc1
    s_waitcnt lgkmcnt(0)
    s_mov_b32 s7, 1146880
    buffer_store_dwordx4 v[76:79], v9, s[48:51], s7 offen sc1
    s_endpgm
.role_m:
    s_setprio 3
    v_lshlrev_b32 v4, 4, v2
    v_add_u32 v4, 34816, v4
    v_mov_b32 v8, 0
    v_mov_b32 v9, 0
    v_mov_b32 v10, 0
    v_mov_b32 v11, 0
    s_mov_b64 exec, 0xff
    ds_write_b128 v4, v[8:11]
    s_mov_b64 exec, -1
    s_waitcnt lgkmcnt(0)
    s_add_u32 s64, s40, 0x1408000
    s_addc_u32 s65, s41, 0
    s_and_b32 s65, s65, 0xffff
    s_mov_b32 s66, 0x100
    s_mov_b32 s67, 0x00020000
    s_mov_b32 s52, s32
    s_and_b32 s53, s33, 0xffff
    s_mov_b32 s54, 0x201000
    s_mov_b32 s55, 0x00020000
    s_mov_b32 s56, s34
    s_and_b32 s57, s35, 0xffff
    s_mov_b32 s58, 0x201000
    s_mov_b32 s59, 0x00020000
    v_mov_b32 v4, 0
    buffer_load_dword v5, v4, s[64:67], 0 offen sc1
    v_and_b32 v7, 7, v2
    v_mul_u32_u24 v8, 1026, v7
    v_bfe_u32 v9, v2, 3, 1
    v_lshl_add_u32 v8, v9, 10, v8
    s_mul_i32 s4, s2, 8208
    s_mov_b64 exec, 0xffff
    buffer_load_ushort v20, v8, s[52:55], s4 offen
    buffer_load_ushort v21, v8, s[56:59], s4 offen
    s_mov_b64 exec, -1
    s_barrier
    s_and_b32 s12, s2, 7
    s_lshr_b32 s13, s2, 3
    v_and_b32 v9, 15, v2
    v_lshlrev_b32 v9, 10, v9
    s_lshl_b32 s7, s2, 2
    s_lshl_b32 s14, s2, 4
    s_add_u32 s14, s14, 65536
    v_mov_b32 v6, 34868
    s_waitcnt vmcnt(2)
    v_readfirstlane_b32 s5, v5
    s_nop 1
    s_add_u32 s5, s5, 0x9e3779ba
    s_or_b32 s5, s5, 1
    v_mov_b32 v5, s5
    ds_write_b32 v6, v5
    s_setprio 1
    s_add_u32 s48, s40, 0x1400000
    s_addc_u32 s49, s41, 0
    s_and_b32 s49, s49, 0xffff
    s_mov_b32 s50, 0x8000
    s_mov_b32 s51, 0x00020000
    v_lshlrev_b32 v9, 1, v9
    s_lshl_b32 s7, s2, 3
    s_waitcnt vmcnt(0)
    s_mov_b64 exec, 0xffff
    v_lshl_or_b32 v20, v21, 16, v20
    v_mov_b32 v21, s5
    buffer_store_dwordx2 v[20:21], v9, s[48:51], s7 offen sc1
    s_mov_b64 exec, -1
    s_add_u32 s68, s2, 3
    s_and_b32 s68, s68, 255
    s_sub_u32 s69, 8, s12
    s_and_b32 s69, s69, 7
    s_lshl_b32 s69, s69, 11
    s_add_u32 s70, s69, 16384
    v_lshlrev_b32 v18, 4, v2
    v_lshlrev_b32 v19, 3, v2
    v_lshrrev_b32 v7, 1, v2
    v_lshlrev_b32 v8, 3, v7
    v_add_u32 v8, s12, v8
    v_mul_u32_u24 v8, 1026, v8
    v_and_b32 v9, 1, v2
    v_lshl_add_u32 v8, v9, 4, v8
    s_lshl_b32 s11, s13, 5
    s_cmp_ge_u32 s12, 5
    s_cselect_b32 s7, 2, 0
    s_add_u32 s11, s11, s7
    v_bfe_u32 v15, v2, 3, 2
    v_lshl_add_u32 v15, v9, 1, v15
    v_and_b32 v14, 3, v15
    v_add_u32 v15, 1, v15
    v_and_b32 v15, 3, v15
    v_lshlrev_b32 v7, 6, v7
    v_add_u32 v7, 16384, v7
    v_lshl_add_u32 v16, v14, 4, v7
    v_lshl_add_u32 v17, v15, 4, v7
    s_and_b32 s8, s13, 3
    s_lshl_b32 s8, s8, 1
    s_mov_b32 s9, s8
    v_mov_b32 v12, 34876
.spin_34:
    ds_read_b32 v13, v12
    s_waitcnt lgkmcnt(0)
    v_readfirstlane_b32 s4, v13
    s_nop 1
    s_cmp_ge_u32 s4, 2
    s_cbranch_scc1 .spun_35
    s_sleep 1
    s_branch .spin_34
.spun_35:
    v_mov_b32 v12, 34820
.spin_36:
    ds_read_b32 v13, v12
    s_waitcnt lgkmcnt(0)
    v_readfirstlane_b32 s4, v13
    s_nop 1
    s_cmp_ge_u32 s4, 5
    s_cbranch_scc1 .spun_37
    s_sleep 1
    s_branch .spin_36
.spun_37:
    s_cmp_ge_u32 s68, 8
    s_cbranch_scc1 .m_nocw1
    buffer_load_dwordx4 v[96:99], v18, s[48:51], s69 offen offset:0 sc1
    buffer_load_dwordx4 v[100:103], v18, s[48:51], s69 offen offset:1024 sc1
    buffer_load_dwordx4 v[104:107], v18, s[48:51], s70 offen offset:0 sc1
    buffer_load_dwordx4 v[108:111], v18, s[48:51], s70 offen offset:1024 sc1
.m_nocw1:
    s_mul_i32 s10, s8, 262656
    s_add_u32 s10, s10, s11
    s_add_u32 s8, s8, 1
    s_and_b32 s8, s8, 7
    buffer_load_dwordx4 v[32:35], v8, s[52:55], s10 offen
    buffer_load_dwordx4 v[36:39], v8, s[56:59], s10 offen
    s_mul_i32 s10, s8, 262656
    s_add_u32 s10, s10, s11
    s_add_u32 s8, s8, 1
    s_and_b32 s8, s8, 7
    buffer_load_dwordx4 v[40:43], v8, s[52:55], s10 offen
    buffer_load_dwordx4 v[44:47], v8, s[56:59], s10 offen
    s_mul_i32 s10, s8, 262656
    s_add_u32 s10, s10, s11
    s_add_u32 s8, s8, 1
    s_and_b32 s8, s8, 7
    buffer_load_dwordx4 v[48:51], v8, s[52:55], s10 offen
    buffer_load_dwordx4 v[52:55], v8, s[56:59], s10 offen
    s_mul_i32 s10, s8, 262656
    s_add_u32 s10, s10, s11
    s_add_u32 s8, s8, 1
    s_and_b32 s8, s8, 7
    buffer_load_dwordx4 v[56:59], v8, s[52:55], s10 offen
    buffer_load_dwordx4 v[60:63], v8, s[56:59], s10 offen
    s_mul_i32 s10, s8, 262656
    s_add_u32 s10, s10, s11
    s_add_u32 s8, s8, 1
    s_and_b32 s8, s8, 7
    buffer_load_dwordx4 v[64:67], v8, s[52:55], s10 offen
    buffer_load_dwordx4 v[68:71], v8, s[56:59], s10 offen
    s_mul_i32 s10, s8, 262656
    s_add_u32 s10, s10, s11
    s_add_u32 s8, s8, 1
    s_and_b32 s8, s8, 7
    buffer_load_dwordx4 v[72:75], v8, s[52:55], s10 offen
    buffer_load_dwordx4 v[76:79], v8, s[56:59], s10 offen
    s_mul_i32 s10, s8, 262656
    s_add_u32 s10, s10, s11
    s_add_u32 s8, s8, 1
    s_and_b32 s8, s8, 7
    buffer_load_dwordx4 v[80:83], v8, s[52:55], s10 offen
    buffer_load_dwordx4 v[84:87], v8, s[56:59], s10 offen
    s_mul_i32 s10, s8, 262656
    s_add_u32 s10, s10, s11
    s_add_u32 s8, s8, 1
    s_and_b32 s8, s8, 7
    buffer_load_dwordx4 v[88:91], v8, s[52:55], s10 offen
    buffer_load_dwordx4 v[92:95], v8, s[56:59], s10 offen
    s_waitcnt vmcnt(14)
    s_lshl_b32 s10, s9, 11
    s_add_u32 s9, s9, 1
    s_and_b32 s9, s9, 7
    v_add_u32 v14, s10, v16
    v_add_u32 v15, s10, v17
    ds_write_b64 v14, v[32:33] offset:0
    ds_write_b64 v15, v[34:35] offset:0
    ds_write_b64 v14, v[36:37] offset:8
    ds_write_b64 v15, v[38:39] offset:8
    s_waitcnt vmcnt(12)
    s_lshl_b32 s10, s9, 11
    s_add_u32 s9, s9, 1
    s_and_b32 s9, s9, 7
    v_add_u32 v14, s10, v16
    v_add_u32 v15, s10, v17
    ds_write_b64 v14, v[40:41] offset:0
    ds_write_b64 v15, v[42:43] offset:0
    ds_write_b64 v14, v[44:45] offset:8
    ds_write_b64 v15, v[46:47] offset:8
    s_waitcnt vmcnt(10)
    s_lshl_b32 s10, s9, 11
    s_add_u32 s9, s9, 1
    s_and_b32 s9, s9, 7
    v_add_u32 v14, s10, v16
    v_add_u32 v15, s10, v17
    ds_write_b64 v14, v[48:49] offset:0
    ds_write_b64 v15, v[50:51] offset:0
    ds_write_b64 v14, v[52:53] offset:8
    ds_write_b64 v15, v[54:55] offset:8
    s_waitcnt vmcnt(8)
    s_lshl_b32 s10, s9, 11
    s_add_u32 s9, s9, 1
    s_and_b32 s9, s9, 7
    v_add_u32 v14, s10, v16
    v_add_u32 v15, s10, v17
    ds_write_b64 v14, v[56:57] offset:0
    ds_write_b64 v15, v[58:59] offset:0
    ds_write_b64 v14, v[60:61] offset:8
    ds_write_b64 v15, v[62:63] offset:8
    s_waitcnt vmcnt(6)
    s_lshl_b32 s10, s9, 11
    s_add_u32 s9, s9, 1
    s_and_b32 s9, s9, 7
    v_add_u32 v14, s10, v16
    v_add_u32 v15, s10, v17
    ds_write_b64 v14, v[64:65] offset:0
    ds_write_b64 v15, v[66:67] offset:0
    ds_write_b64 v14, v[68:69] offset:8
    ds_write_b64 v15, v[70:71] offset:8
    s_waitcnt vmcnt(4)
    s_lshl_b32 s10, s9, 11
    s_add_u32 s9, s9, 1
    s_and_b32 s9, s9, 7
    v_add_u32 v14, s10, v16
    v_add_u32 v15, s10, v17
    ds_write_b64 v14, v[72:73] offset:0
    ds_write_b64 v15, v[74:75] offset:0
    ds_write_b64 v14, v[76:77] offset:8
    ds_write_b64 v15, v[78:79] offset:8
    s_waitcnt vmcnt(2)
    s_lshl_b32 s10, s9, 11
    s_add_u32 s9, s9, 1
    s_and_b32 s9, s9, 7
    v_add_u32 v14, s10, v16
    v_add_u32 v15, s10, v17
    ds_write_b64 v14, v[80:81] offset:0
    ds_write_b64 v15, v[82:83] offset:0
    ds_write_b64 v14, v[84:85] offset:8
    ds_write_b64 v15, v[86:87] offset:8
    s_waitcnt vmcnt(0)
    s_lshl_b32 s10, s9, 11
    s_add_u32 s9, s9, 1
    s_and_b32 s9, s9, 7
    v_add_u32 v14, s10, v16
    v_add_u32 v15, s10, v17
    ds_write_b64 v14, v[88:89] offset:0
    ds_write_b64 v15, v[90:91] offset:0
    ds_write_b64 v14, v[92:93] offset:8
    ds_write_b64 v15, v[94:95] offset:8
    s_cmp_ge_u32 s68, 8
    s_cbranch_scc1 .m_nocw2
    s_mov_b32 s6, 524288
.m_cwpoll:
    s_waitcnt vmcnt(0)
    v_mov_b32 v12, 0
    v_xor_b32 v13, s5, v97
    v_xor_b32 v14, s5, v99
    v_or3_b32 v12, v12, v13, v14
    v_xor_b32 v13, s5, v101
    v_xor_b32 v14, s5, v103
    v_or3_b32 v12, v12, v13, v14
    v_xor_b32 v13, s5, v105
    v_xor_b32 v14, s5, v107
    v_or3_b32 v12, v12, v13, v14
    v_xor_b32 v13, s5, v109
    v_xor_b32 v14, s5, v111
    v_or3_b32 v12, v12, v13, v14
    v_cmp_ne_u32 vcc, 0, v12
    s_nop 1
    s_cmp_eq_u64 vcc, 0
    s_cbranch_scc1 .m_cwgot
    s_sub_u32 s6, s6, 1
    s_cmp_eq_u32 s6, 0
    s_cbranch_scc1 .m_cwgot
    buffer_load_dwordx4 v[96:99], v18, s[48:51], s69 offen offset:0 sc1
    buffer_load_dwordx4 v[100:103], v18, s[48:51], s69 offen offset:1024 sc1
    buffer_load_dwordx4 v[104:107], v18, s[48:51], s70 offen offset:0 sc1
    buffer_load_dwordx4 v[108:111], v18, s[48:51], s70 offen offset:1024 sc1
    s_branch .m_cwpoll
.m_cwgot:
    v_mov_b32 v97, v98
    ds_write_b64 v19, v[96:97] offset:32768
    v_mov_b32 v101, v102
    ds_write_b64 v19, v[100:101] offset:33280
    v_mov_b32 v105, v106
    ds_write_b64 v19, v[104:105] offset:33792
    v_mov_b32 v109, v110
    ds_write_b64 v19, v[108:109] offset:34304
.m_nocw2:
    v_mov_b32 v12, 34836
    v_mov_b32 v13, 1
    s_waitcnt lgkmcnt(0)
    s_mov_b64 exec, 1
    ds_add_u32 v12, v13
    s_mov_b64 exec, -1
    s_branch .wsum
.wsum_ret_m:
    s_endpgm
.wsum:
    s_setprio 1
    s_sub_u32 s101, s3, 4
    s_mul_i32 s100, s101, 31680
    s_add_u32 s100, s100, 34944
    v_lshlrev_b32 v16, 4, v2
    v_add_u32 v16, s100, v16
    s_mov_b32 s100, 0xffff0000
    v_mov_b32 v4, 34904
    v_lshl_add_u32 v4, s101, 2, v4
.spin_38:
    ds_read_b32 v5, v4
    s_waitcnt lgkmcnt(0)
    v_readfirstlane_b32 s4, v5
    s_nop 1
    s_cmp_ge_u32 s4, 1
    s_cbranch_scc1 .spun_39
    s_sleep 2
    s_branch .spin_38
.spun_39:
    ds_read_b128 v[56:59], v16 offset:14288
    ds_read_b128 v[60:63], v16 offset:14304
    ds_read_b128 v[64:67], v16 offset:15312
    ds_read_b128 v[68:71], v16 offset:15328
    ds_read_b128 v[72:75], v16 offset:16336
    ds_read_b128 v[76:79], v16 offset:16352
    s_waitcnt lgkmcnt(4)
    v_lshlrev_b32 v18, 16, v56
    v_and_b32 v19, s100, v56
    v_lshlrev_b32 v20, 16, v57
    v_and_b32 v21, s100, v57
    v_lshlrev_b32 v22, 16, v58
    v_and_b32 v23, s100, v58
    v_lshlrev_b32 v24, 16, v59
    v_and_b32 v25, s100, v59
    v_lshlrev_b32 v26, 16, v60
    v_and_b32 v27, s100, v60
    v_lshlrev_b32 v28, 16, v61
    v_and_b32 v29, s100, v61
    v_lshlrev_b32 v30, 16, v62
    v_and_b32 v31, s100, v62
    v_lshlrev_b32 v32, 16, v63
    v_and_b32 v33, s100, v63
    v_add_f32 v34, v18, v19
    v_add_f32 v35, v19, v20
    v_add_f32 v36, v20, v21
    v_add_f32 v37, v21, v22
    v_add_f32 v38, v22, v23
    v_add_f32 v39, v23, v24
    v_add_f32 v40, v24, v25
    v_add_f32 v41, v25, v26
    v_add_f32 v42, v26, v27
    v_add_f32 v43, v27, v28
    v_add_f32 v44, v28, v29
    v_add_f32 v45, v29, v30
    v_add_f32 v46, v30, v31
    v_add_f32 v47, v31, v32
    v_add_f32 v48, v32, v33
    v_add_f32 v20, v34, v20
    v_add_f32 v21, v35, v21
    v_add_f32 v22, v36, v22
    v_add_f32 v23, v37, v23
    v_add_f32 v24, v38, v24
    v_add_f32 v25, v39, v25
    v_add_f32 v26, v40, v26
    v_add_f32 v27, v41, v27
    v_add_f32 v28, v42, v28
    v_add_f32 v29, v43, v29
    v_add_f32 v30, v44, v30
    v_cvt_pk_bf16_f32 v56, v23, v24
    v_cvt_pk_bf16_f32 v57, v25, v26
    v_cvt_pk_bf16_f32 v58, v27, v28
    v_cvt_pk_bf16_f32 v59, v29, v30
    ds_write_b128 v16, v[56:59] offset:23904
    v_add_f32 v20, v20, v37
    v_add_f32 v21, v21, v38
    v_add_f32 v22, v22, v39
    v_add_f32 v23, v23, v40
    v_add_f32 v24, v24, v41
    v_add_f32 v25, v25, v42
    v_add_f32 v26, v26, v43
    v_add_f32 v27, v27, v44
    v_add_f32 v28, v28, v45
    v_add_f32 v29, v29, v46
    v_cvt_pk_bf16_f32 v60, v22, v23
    v_cvt_pk_bf16_f32 v61, v24, v25
    v_cvt_pk_bf16_f32 v62, v26, v27
    v_cvt_pk_bf16_f32 v63, v28, v29
    ds_write_b128 v16, v[60:63] offset:20704
    v_add_f32 v20, v20, v39
    v_add_f32 v21, v21, v40
    v_add_f32 v22, v22, v41
    v_add_f32 v23, v23, v42
    v_add_f32 v24, v24, v43
    v_add_f32 v25, v25, v44
    v_add_f32 v26, v26, v45
    v_add_f32 v27, v27, v46
    v_add_f32 v28, v28, v47
    v_cvt_pk_bf16_f32 v56, v21, v22
    v_cvt_pk_bf16_f32 v57, v23, v24
    v_cvt_pk_bf16_f32 v58, v25, v26
    v_cvt_pk_bf16_f32 v59, v27, v28
    ds_write_b128 v16, v[56:59] offset:29104
    v_add_f32 v20, v20, v41
    v_add_f32 v21, v21, v42
    v_add_f32 v22, v22, v43
    v_add_f32 v23, v23, v44
    v_add_f32 v24, v24, v45
    v_add_f32 v25, v25, v46
    v_add_f32 v26, v26, v47
    v_add_f32 v27, v27, v48
    v_cvt_pk_bf16_f32 v60, v20, v21
    v_cvt_pk_bf16_f32 v61, v22, v23
    v_cvt_pk_bf16_f32 v62, v24, v25
    v_cvt_pk_bf16_f32 v63, v26, v27
    ds_write_b128 v16, v[60:63] offset:27008
    s_waitcnt lgkmcnt(6)
    v_lshlrev_b32 v18, 16, v64
    v_and_b32 v19, s100, v64
    v_lshlrev_b32 v20, 16, v65
    v_and_b32 v21, s100, v65
    v_lshlrev_b32 v22, 16, v66
    v_and_b32 v23, s100, v66
    v_lshlrev_b32 v24, 16, v67
    v_and_b32 v25, s100, v67
    v_lshlrev_b32 v26, 16, v68
    v_and_b32 v27, s100, v68
    v_lshlrev_b32 v28, 16, v69
    v_and_b32 v29, s100, v69
    v_lshlrev_b32 v30, 16, v70
    v_and_b32 v31, s100, v70
    v_lshlrev_b32 v32, 16, v71
    v_and_b32 v33, s100, v71
    v_add_f32 v34, v18, v19
    v_add_f32 v35, v19, v20
    v_add_f32 v36, v20, v21
    v_add_f32 v37, v21, v22
    v_add_f32 v38, v22, v23
    v_add_f32 v39, v23, v24
    v_add_f32 v40, v24, v25
    v_add_f32 v41, v25, v26
    v_add_f32 v42, v26, v27
    v_add_f32 v43, v27, v28
    v_add_f32 v44, v28, v29
    v_add_f32 v45, v29, v30
    v_add_f32 v46, v30, v31
    v_add_f32 v47, v31, v32
    v_add_f32 v48, v32, v33
    v_add_f32 v20, v34, v20
    v_add_f32 v21, v35, v21
    v_add_f32 v22, v36, v22
    v_add_f32 v23, v37, v23
    v_add_f32 v24, v38, v24
    v_add_f32 v25, v39, v25
    v_add_f32 v26, v40, v26
    v_add_f32 v27, v41, v27
    v_add_f32 v28, v42, v28
    v_add_f32 v29, v43, v29
    v_add_f32 v30, v44, v30
    v_cvt_pk_bf16_f32 v64, v23, v24
    v_cvt_pk_bf16_f32 v65, v25, v26
    v_cvt_pk_bf16_f32 v66, v27, v28
    v_cvt_pk_bf16_f32 v67, v29, v30
    ds_write_b128 v16, v[64:67] offset:24928
    v_add_f32 v20, v20, v37
    v_add_f32 v21, v21, v38
    v_add_f32 v22, v22, v39
    v_add_f32 v23, v23, v40
    v_add_f32 v24, v24, v41
    v_add_f32 v25, v25, v42
    v_add_f32 v26, v26, v43
    v_add_f32 v27, v27, v44
    v_add_f32 v28, v28, v45
    v_add_f32 v29, v29, v46
    v_cvt_pk_bf16_f32 v68, v22, v23
    v_cvt_pk_bf16_f32 v69, v24, v25
    v_cvt_pk_bf16_f32 v70, v26, v27
    v_cvt_pk_bf16_f32 v71, v28, v29
    ds_write_b128 v16, v[68:71] offset:21728
    v_add_f32 v20, v20, v39
    v_add_f32 v21, v21, v40
    v_add_f32 v22, v22, v41
    v_add_f32 v23, v23, v42
    v_add_f32 v24, v24, v43
    v_add_f32 v25, v25, v44
    v_add_f32 v26, v26, v45
    v_add_f32 v27, v27, v46
    v_add_f32 v28, v28, v47
    v_cvt_pk_bf16_f32 v64, v21, v22
    v_cvt_pk_bf16_f32 v65, v23, v24
    v_cvt_pk_bf16_f32 v66, v25, v26
    v_cvt_pk_bf16_f32 v67, v27, v28
    ds_write_b128 v16, v[64:67] offset:30128
    v_add_f32 v20, v20, v41
    v_add_f32 v21, v21, v42
    v_add_f32 v22, v22, v43
    v_add_f32 v23, v23, v44
    v_add_f32 v24, v24, v45
    v_add_f32 v25, v25, v46
    v_add_f32 v26, v26, v47
    v_add_f32 v27, v27, v48
    v_cvt_pk_bf16_f32 v68, v20, v21
    v_cvt_pk_bf16_f32 v69, v22, v23
    v_cvt_pk_bf16_f32 v70, v24, v25
    v_cvt_pk_bf16_f32 v71, v26, v27
    ds_write_b128 v16, v[68:71] offset:28032
    s_waitcnt lgkmcnt(8)
    v_lshlrev_b32 v20, 16, v73
    v_and_b32 v21, s100, v73
    v_lshlrev_b32 v22, 16, v74
    v_and_b32 v23, s100, v74
    v_lshlrev_b32 v24, 16, v75
    v_and_b32 v25, s100, v75
    v_lshlrev_b32 v26, 16, v76
    v_and_b32 v27, s100, v76
    v_lshlrev_b32 v28, 16, v77
    v_and_b32 v29, s100, v77
    v_lshlrev_b32 v30, 16, v78
    v_and_b32 v31, s100, v78
    v_add_f32 v36, v20, v21
    v_add_f32 v37, v21, v22
    v_add_f32 v38, v22, v23
    v_add_f32 v39, v23, v24
    v_add_f32 v40, v24, v25
    v_add_f32 v41, v25, v26
    v_add_f32 v42, v26, v27
    v_add_f32 v43, v27, v28
    v_add_f32 v44, v28, v29
    v_add_f32 v45, v29, v30
    v_add_f32 v46, v30, v31
    v_add_f32 v22, v36, v22
    v_add_f32 v23, v37, v23
    v_add_f32 v24, v38, v24
    v_add_f32 v25, v39, v25
    v_add_f32 v26, v40, v26
    v_add_f32 v27, v41, v27
    v_add_f32 v28, v42, v28
    v_add_f32 v29, v43, v29
    v_add_f32 v30, v44, v30
    v_cvt_pk_bf16_f32 v72, v23, v24
    v_cvt_pk_bf16_f32 v73, v25, v26
    v_cvt_pk_bf16_f32 v74, v27, v28
    v_cvt_pk_bf16_f32 v75, v29, v30
    ds_write_b128 v16, v[72:75] offset:25952
    v_add_f32 v22, v22, v39
    v_add_f32 v23, v23, v40
    v_add_f32 v24, v24, v41
    v_add_f32 v25, v25, v42
    v_add_f32 v26, v26, v43
    v_add_f32 v27, v27, v44
    v_add_f32 v28, v28, v45
    v_add_f32 v29, v29, v46
    v_cvt_pk_bf16_f32 v76, v22, v23
    v_cvt_pk_bf16_f32 v77, v24, v25
    v_cvt_pk_bf16_f32 v78, v26, v27
    v_cvt_pk_bf16_f32 v79, v28, v29
    ds_write_b128 v16, v[76:79] offset:22752
    v_mov_b32 v4, 34888
    v_lshl_add_u32 v4, s101, 2, v4
    v_mov_b32 v5, 1
    s_waitcnt lgkmcnt(0)
    s_mov_b64 exec, 1
    ds_add_u32 v4, v5
    s_mov_b64 exec, -1
    s_cmp_eq_u32 s3, 4
    s_cbranch_scc1 .wsum_ret_b
    s_cmp_eq_u32 s3, 7
    s_cbranch_scc1 .wsum_ret_m
    s_branch .wsum_ret_t
.role_a:
    s_and_b32 s10, s3, 3
    s_lshl_b32 s9, s2, 2
    s_add_u32 s9, s9, s10
    s_mul_i32 s10, s10, 31680
    s_add_u32 s10, s10, 34944
    s_lshl_b32 s68, s9, 8
    s_lshl_b32 s69, s9, 1
    v_lshlrev_b32 v37, 3, v2
    v_add_u32 v37, s10, v37
    v_lshlrev_b32 v35, 2, v2
    v_mov_b32 v36, 0
    s_waitcnt lgkmcnt(0)
    s_mov_b32 s44, s18
    s_and_b32 s45, s19, 0xffff
    s_mov_b32 s46, 0x40000
    s_mov_b32 s47, 0x00020000
    s_mov_b32 s48, s26
    s_and_b32 s49, s27, 0xffff
    s_mov_b32 s50, 0x800
    s_mov_b32 s51, 0x00020000
    s_mov_b32 s52, s20
    s_and_b32 s53, s21, 0xffff
    s_mov_b32 s54, 0x40000
    s_mov_b32 s55, 0x00020000
    buffer_load_dword v40, v35, s[44:47], s68 offen
    buffer_load_ushort v44, v36, s[48:51], s69 offen
    buffer_load_dword v41, v35, s[52:55], s68 offen
    s_mov_b32 s44, s22
    s_and_b32 s45, s23, 0xffff
    s_mov_b32 s46, 0x40000
    s_mov_b32 s47, 0x00020000
    s_mov_b32 s48, s24
    s_and_b32 s49, s25, 0xffff
    s_mov_b32 s50, 0x40000
    s_mov_b32 s51, 0x00020000
    s_mov_b32 s52, s28
    s_and_b32 s53, s29, 0xffff
    s_mov_b32 s54, 0x800
    s_mov_b32 s55, 0x00020000
    buffer_load_dword v42, v35, s[44:47], s68 offen
    buffer_load_dword v43, v35, s[48:51], s68 offen
    buffer_load_ushort v17, v36, s[52:55], s69 offen
    s_barrier
    s_setprio 1
    v_lshlrev_b32 v3, 4, v2
    s_mul_i32 s15, s9, 4224
    s_add_u32 s15, s15, 0
    v_add_u32 v23, s10, v3
    s_lshl_b32 s14, s2, 4
    s_add_u32 s14, s14, 12288
    v_and_b32 v4, 31, v2
    v_lshrrev_b32 v5, 5, v2
    v_lshlrev_b32 v6, 4, v4
    s_add_u32 s11, s10, 15616
    v_sub_u32 v6, s11, v6
    v_lshlrev_b32 v7, 3, v5
    v_sub_u32 v20, v6, v7
    v_lshlrev_b32 v7, 9, v5
    v_sub_u32 v21, v6, v7
    v_sub_u32 v22, v21, v7
    v_add_u32 v22, 1520, v22
    v_add_u32 v21, 3056, v21
    v_add_u32 v20, 3576, v20
    v_lshlrev_b32 v7, 4, v5
    v_add_u32 v7, s10, v7
    v_add_u32 v6, 28, v4
    v_mul_u32_u24 v6, 528, v6
    v_add_u32 v19, v6, v7
    v_mov_b32 v6, v4
    v_cmp_lt_u32 vcc, 11, v4
    s_nop 1
    v_subbrev_co_u32 v6, vcc, 0, v6, vcc
    v_cmp_lt_u32 vcc, 15, v4
    s_nop 1
    v_subbrev_co_u32 v6, vcc, 0, v6, vcc
    v_cmp_lt_u32 vcc, 19, v4
    s_nop 1
    v_subbrev_co_u32 v6, vcc, 0, v6, vcc
    v_cmp_lt_u32 vcc, 23, v4
    s_nop 1
    v_subbrev_co_u32 v6, vcc, 0, v6, vcc
    v_mul_u32_u24 v6, 528, v6
    v_add_u32 v18, v6, v7
    v_and_b32 v7, 1, v4
    v_cmp_eq_u32 s[70:71], 1, v7
    v_and_b32 v26, 15, v2
    v_lshrrev_b32 v27, 4, v2
    v_lshlrev_b32 v28, 4, v27
    v_lshlrev_b32 v29, 3, v26
    v_sub_u32 v24, v28, v29
    s_add_u32 s6, s11, 120
    v_add_u32 v24, s6, v24
    v_and_b32 v30, 3, v26
    v_mul_u32_u24 v30, 4640, v30
    v_lshrrev_b32 v31, 2, v26
    v_lshl_add_u32 v30, v31, 7, v30
    v_add3_u32 v25, v30, v28, s10
    v_lshlrev_b32 v6, 7, v5
    v_lshl_add_u32 v7, v4, 2, v6
    v_sub_u32 v21, s10, v7
    v_add_u32 v21, 20220, v21
    v_lshl_add_u32 v7, v4, 1, v6
    v_sub_u32 v22, s10, v7
    v_add_u32 v22, 20542, v22
    v_and_b32 v6, 3, v2
    v_lshl_add_u32 v6, v6, 3, s10
    v_bfe_u32 v7, v2, 2, 1
    v_cmp_eq_u32 vcc, 1, v7
    v_mov_b32 v7, 20680
    v_mov_b32 v30, 23880
    v_cndmask_b32 v13, v7, v30, vcc
    v_mov_b32 v7, 26984
    v_mov_b32 v30, 29080
    v_cndmask_b32 v14, v7, v30, vcc
    v_mov_b32 v7, 384
    v_mov_b32 v30, 14296
    v_cndmask_b32 v15, v7, v30, vcc
    v_lshl_add_u32 v7, v27, 6, v6
    v_lshl_add_u32 v7, v31, 3, v7
    v_add_u32 v13, v13, v7
    v_lshl_add_u32 v7, v27, 7, v6
    v_lshl_add_u32 v30, v31, 4, v7
    v_add_u32 v14, v14, v30
    v_lshrrev_b32 v30, 1, v31
    v_lshl_add_u32 v30, v30, 5, v7
    v_add_u32 v15, v15, v30
    v_lshlrev_b32 v7, 2, v26
    v_sub_u32 v7, v28, v7
    v_add_u32 v7, s10, v7
    v_add_u32 v16, 20412, v7
    v_lshrrev_b32 v7, 1, v26
    v_add_u32 v7, v7, v27
    v_and_b32 v7, 3, v7
    v_lshlrev_b32 v7, 4, v7
    v_lshl_add_u32 v7, v26, 6, v7
    v_add_u32 v4, s10, v7
    v_lshrrev_b32 v7, 3, v2
    v_add_u32 v7, v7, v2
    v_and_b32 v7, 3, v7
    v_and_b32 v29, 60, v2
    v_add_u32 v7, v7, v29
    v_lshl_add_u32 v29, v7, 4, s10
    v_lshlrev_b32 v5, 2, v27
    v_sub_u32 v5, v26, v5
    s_waitcnt vmcnt(3)
    s_mov_b32 s4, 0x3fb8aa3b
    s_mov_b32 s5, 0x32a57060
    s_mov_b32 s6, 0x3f317218
    s_mov_b32 s7, 0xffff0000
    s_nop 0
    v_lshlrev_b32 v48, 16, v40
    v_and_b32 v49, s7, v40
    v_lshlrev_b32 v56, 16, v44
    v_mul_f32 v58, s4, v56
    v_mul_f32 v60, s4, v48
    v_mul_f32 v62, s4, v49
    v_fma_f32 v59, v56, s4, -v58
    v_fma_f32 v61, v48, s4, -v60
    v_fma_f32 v63, v49, s4, -v62
    v_fma_f32 v59, v56, s5, v59
    v_fma_f32 v61, v48, s5, v61
    v_fma_f32 v63, v49, s5, v63
    v_exp_f32 v58, v58
    v_exp_f32 v60, v60
    v_exp_f32 v62, v62
    v_mul_f32 v59, s6, v59
    v_mul_f32 v61, s6, v61
    v_mul_f32 v63, s6, v63
    v_fma_f32 v56, v58, v59, v58
    v_fma_f32 v48, v60, v61, v60
    v_fma_f32 v49, v62, v63, v62
    v_lshlrev_b32 v50, 16, v41
    v_and_b32 v51, s7, v41
    v_cvt_pk_bf16_f32 v56, v56, v56
    v_cvt_pk_bf16_f32 v40, v48, v49
    v_and_b32 v56, s7, v56
    v_lshlrev_b32 v48, 16, v40
    v_and_b32 v49, s7, v40
    v_mul_f32 v50, v50, v56
    v_mul_f32 v51, v51, v56
    v_mul_f32 v48, v48, v56
    v_mul_f32 v49, v49, v56
    v_mul_f32 v50, 0.15915494, v50
    v_mul_f32 v51, 0.15915494, v51
    v_mul_f32 v48, 0xbfb8aa3b, v48
    v_mul_f32 v49, 0xbfb8aa3b, v49
    v_mul_f32 v59, 0x41000000, v50
    v_mul_f32 v61, 0x41000000, v51
    v_mul_f32 v58, 0x41000000, v48
    v_mul_f32 v60, 0x41000000, v49
    v_fract_f32 v59, v59
    v_fract_f32 v61, v61
    v_exp_f32 v58, v58
    v_exp_f32 v60, v60
    v_cos_f32 v68, v59
    v_cos_f32 v69, v61
    v_sin_f32 v70, v59
    v_sin_f32 v71, v61
    v_mul_f32 v68, v68, v58
    v_mul_f32 v69, v69, v60
    v_mul_f32 v70, v70, v58
    v_mul_f32 v71, v71, v60
    v_pk_mul_f32 v[76:77], v[70:71], v[70:71]
    v_pk_mul_f32 v[78:79], v[70:71], v[68:69]
    v_pk_fma_f32 v[64:65], v[68:69], v[68:69], v[76:77] neg_lo:[0,0,1] neg_hi:[0,0,1]
    v_pk_fma_f32 v[66:67], v[68:69], v[70:71], v[78:79]
    v_mov_b32 v88, 0x3f80
    v_mov_b32 v89, 0x3f80
    ds_write_b64 v37, v[88:89] offset:14784
    v_cvt_pk_bf16_f32 v90, v68, v70
    v_cvt_pk_bf16_f32 v91, v69, v71
    ds_write_b64 v37, v[90:91] offset:15312
    v_pk_mul_f32 v[76:77], v[66:67], v[70:71]
    v_pk_mul_f32 v[78:79], v[66:67], v[68:69]
    v_pk_fma_f32 v[72:73], v[64:65], v[68:69], v[76:77] neg_lo:[0,0,1] neg_hi:[0,0,1]
    v_pk_fma_f32 v[74:75], v[64:65], v[70:71], v[78:79]
    v_cvt_pk_bf16_f32 v92, v64, v66
    v_cvt_pk_bf16_f32 v93, v65, v67
    ds_write_b64 v37, v[92:93] offset:15840
    v_cvt_pk_bf16_f32 v94, v72, v74
    v_cvt_pk_bf16_f32 v95, v73, v75
    ds_write_b64 v37, v[94:95] offset:16368
    v_pk_mul_f32 v[76:77], v[70:71], v[74:75]
    v_pk_mul_f32 v[78:79], v[70:71], v[72:73]
    v_pk_mul_f32 v[80:81], v[66:67], v[74:75]
    v_pk_mul_f32 v[82:83], v[66:67], v[72:73]
    v_pk_mul_f32 v[84:85], v[74:75], v[74:75]
    v_pk_mul_f32 v[86:87], v[74:75], v[72:73]
    v_pk_fma_f32 v[104:105], v[68:69], v[72:73], v[76:77] neg_lo:[0,0,1] neg_hi:[0,0,1]
    v_pk_fma_f32 v[106:107], v[68:69], v[74:75], v[78:79]
    v_pk_fma_f32 v[108:109], v[64:65], v[72:73], v[80:81] neg_lo:[0,0,1] neg_hi:[0,0,1]
    v_pk_fma_f32 v[110:111], v[64:65], v[74:75], v[82:83]
    v_pk_fma_f32 v[112:113], v[72:73], v[72:73], v[84:85] neg_lo:[0,0,1] neg_hi:[0,0,1]
    v_pk_fma_f32 v[114:115], v[72:73], v[74:75], v[86:87]
    v_pk_mul_f32 v[76:77], v[106:107], v[74:75]
    v_pk_mul_f32 v[78:79], v[106:107], v[72:73]
    v_pk_mul_f32 v[80:81], v[110:111], v[74:75]
    v_pk_mul_f32 v[82:83], v[110:111], v[72:73]
    v_pk_mul_f32 v[84:85], v[114:115], v[74:75]
    v_pk_mul_f32 v[86:87], v[114:115], v[72:73]
    v_pk_fma_f32 v[116:117], v[104:105], v[72:73], v[76:77] neg_lo:[0,0,1] neg_hi:[0,0,1]
    v_pk_fma_f32 v[118:119], v[104:105], v[74:75], v[78:79]
    v_pk_fma_f32 v[120:121], v[108:109], v[72:73], v[80:81] neg_lo:[0,0,1] neg_hi:[0,0,1]
    v_pk_fma_f32 v[122:123], v[108:109], v[74:75], v[82:83]
    v_pk_fma_f32 v[124:125], v[112:113], v[72:73], v[84:85] neg_lo:[0,0,1] neg_hi:[0,0,1]
    v_pk_fma_f32 v[126:127], v[112:113], v[74:75], v[86:87]
    v_cvt_pk_bf16_f32 v88, v104, v106
    v_cvt_pk_bf16_f32 v89, v105, v107
    ds_write_b64 v37, v[88:89] offset:16896
    v_cvt_pk_bf16_f32 v90, v108, v110
    v_cvt_pk_bf16_f32 v91, v109, v111
    ds_write_b64 v37, v[90:91] offset:17424
    v_cvt_pk_bf16_f32 v92, v112, v114
    v_cvt_pk_bf16_f32 v93, v113, v115
    ds_write_b64 v37, v[92:93] offset:17952
    v_pk_mul_f32 v[76:77], v[118:119], v[74:75]
    v_pk_mul_f32 v[78:79], v[118:119], v[72:73]
    v_pk_mul_f32 v[80:81], v[122:123], v[74:75]
    v_pk_mul_f32 v[82:83], v[122:123], v[72:73]
    v_pk_mul_f32 v[84:85], v[126:127], v[74:75]
    v_pk_mul_f32 v[86:87], v[126:127], v[72:73]
    v_pk_fma_f32 v[128:129], v[116:117], v[72:73], v[76:77] neg_lo:[0,0,1] neg_hi:[0,0,1]
    v_pk_fma_f32 v[130:131], v[116:117], v[74:75], v[78:79]
    v_pk_fma_f32 v[132:133], v[120:121], v[72:73], v[80:81] neg_lo:[0,0,1] neg_hi:[0,0,1]
    v_pk_fma_f32 v[134:135], v[120:121], v[74:75], v[82:83]
    v_pk_fma_f32 v[136:137], v[124:125], v[72:73], v[84:85] neg_lo:[0,0,1] neg_hi:[0,0,1]
    v_pk_fma_f32 v[138:139], v[124:125], v[74:75], v[86:87]
    v_cvt_pk_bf16_f32 v94, v116, v118
    v_cvt_pk_bf16_f32 v95, v117, v119
    ds_write_b64 v37, v[94:95] offset:18480
    v_cvt_pk_bf16_f32 v88, v120, v122
    v_cvt_pk_bf16_f32 v89, v121, v123
    ds_write_b64 v37, v[88:89] offset:19008
    v_cvt_pk_bf16_f32 v90, v124, v126
    v_cvt_pk_bf16_f32 v91, v125, v127
    ds_write_b64 v37, v[90:91] offset:19536
    v_pk_mul_f32 v[76:77], v[130:131], v[74:75]
    v_pk_mul_f32 v[78:79], v[130:131], v[72:73]
    v_pk_mul_f32 v[80:81], v[134:135], v[74:75]
    v_pk_mul_f32 v[82:83], v[134:135], v[72:73]
    v_pk_mul_f32 v[84:85], v[138:139], v[74:75]
    v_pk_mul_f32 v[86:87], v[138:139], v[72:73]
    v_pk_fma_f32 v[140:141], v[128:129], v[72:73], v[76:77] neg_lo:[0,0,1] neg_hi:[0,0,1]
    v_pk_fma_f32 v[142:143], v[128:129], v[74:75], v[78:79]
    v_pk_fma_f32 v[144:145], v[132:133], v[72:73], v[80:81] neg_lo:[0,0,1] neg_hi:[0,0,1]
    v_pk_fma_f32 v[146:147], v[132:133], v[74:75], v[82:83]
    v_pk_fma_f32 v[148:149], v[136:137], v[72:73], v[84:85] neg_lo:[0,0,1] neg_hi:[0,0,1]
    v_pk_fma_f32 v[150:151], v[136:137], v[74:75], v[86:87]
    v_cvt_pk_bf16_f32 v92, v128, v130
    v_cvt_pk_bf16_f32 v93, v129, v131
    ds_write_b64 v37, v[92:93] offset:20064
    v_cvt_pk_bf16_f32 v94, v132, v134
    v_cvt_pk_bf16_f32 v95, v133, v135
    ds_write_b64 v37, v[94:95] offset:20592
    v_cvt_pk_bf16_f32 v88, v136, v138
    v_cvt_pk_bf16_f32 v89, v137, v139
    ds_write_b64 v37, v[88:89] offset:21120
    v_pk_mul_f32 v[76:77], v[142:143], v[74:75]
    v_pk_mul_f32 v[78:79], v[142:143], v[72:73]
    v_pk_mul_f32 v[80:81], v[146:147], v[74:75]
    v_pk_mul_f32 v[82:83], v[146:147], v[72:73]
    v_pk_mul_f32 v[84:85], v[150:151], v[74:75]
    v_pk_mul_f32 v[86:87], v[150:151], v[72:73]
    v_pk_fma_f32 v[152:153], v[140:141], v[72:73], v[76:77] neg_lo:[0,0,1] neg_hi:[0,0,1]
    v_pk_fma_f32 v[154:155], v[140:141], v[74:75], v[78:79]
    v_pk_fma_f32 v[104:105], v[144:145], v[72:73], v[80:81] neg_lo:[0,0,1] neg_hi:[0,0,1]
    v_pk_fma_f32 v[106:107], v[144:145], v[74:75], v[82:83]
    v_pk_fma_f32 v[108:109], v[148:149], v[72:73], v[84:85] neg_lo:[0,0,1] neg_hi:[0,0,1]
    v_pk_fma_f32 v[110:111], v[148:149], v[74:75], v[86:87]
    v_cvt_pk_bf16_f32 v90, v140, v142
    v_cvt_pk_bf16_f32 v91, v141, v143
    ds_write_b64 v37, v[90:91] offset:21648
    v_cvt_pk_bf16_f32 v92, v144, v146
    v_cvt_pk_bf16_f32 v93, v145, v147
    ds_write_b64 v37, v[92:93] offset:22176
    v_cvt_pk_bf16_f32 v94, v148, v150
    v_cvt_pk_bf16_f32 v95, v149, v151
    ds_write_b64 v37, v[94:95] offset:22704
    v_pk_mul_f32 v[76:77], v[154:155], v[74:75]
    v_pk_mul_f32 v[78:79], v[154:155], v[72:73]
    v_pk_mul_f32 v[80:81], v[106:107], v[74:75]
    v_pk_mul_f32 v[82:83], v[106:107], v[72:73]
    v_pk_mul_f32 v[84:85], v[110:111], v[74:75]
    v_pk_mul_f32 v[86:87], v[110:111], v[72:73]
    v_pk_fma_f32 v[112:113], v[152:153], v[72:73], v[76:77] neg_lo:[0,0,1] neg_hi:[0,0,1]
    v_pk_fma_f32 v[114:115], v[152:153], v[74:75], v[78:79]
    v_pk_fma_f32 v[116:117], v[104:105], v[72:73], v[80:81] neg_lo:[0,0,1] neg_hi:[0,0,1]
    v_pk_fma_f32 v[118:119], v[104:105], v[74:75], v[82:83]
    v_pk_fma_f32 v[120:121], v[108:109], v[72:73], v[84:85] neg_lo:[0,0,1] neg_hi:[0,0,1]
    v_pk_fma_f32 v[122:123], v[108:109], v[74:75], v[86:87]
    v_cvt_pk_bf16_f32 v88, v152, v154
    v_cvt_pk_bf16_f32 v89, v153, v155
    ds_write_b64 v37, v[88:89] offset:23232
    v_cvt_pk_bf16_f32 v90, v104, v106
    v_cvt_pk_bf16_f32 v91, v105, v107
    ds_write_b64 v37, v[90:91] offset:23760
    v_cvt_pk_bf16_f32 v92, v108, v110
    v_cvt_pk_bf16_f32 v93, v109, v111
    ds_write_b64 v37, v[92:93] offset:24288
    v_pk_mul_f32 v[76:77], v[114:115], v[74:75]
    v_pk_mul_f32 v[78:79], v[114:115], v[72:73]
    v_pk_mul_f32 v[80:81], v[118:119], v[74:75]
    v_pk_mul_f32 v[82:83], v[118:119], v[72:73]
    v_pk_mul_f32 v[84:85], v[122:123], v[74:75]
    v_pk_mul_f32 v[86:87], v[122:123], v[72:73]
    v_pk_fma_f32 v[124:125], v[112:113], v[72:73], v[76:77] neg_lo:[0,0,1] neg_hi:[0,0,1]
    v_pk_fma_f32 v[126:127], v[112:113], v[74:75], v[78:79]
    v_pk_fma_f32 v[128:129], v[116:117], v[72:73], v[80:81] neg_lo:[0,0,1] neg_hi:[0,0,1]
    v_pk_fma_f32 v[130:131], v[116:117], v[74:75], v[82:83]
    v_pk_fma_f32 v[132:133], v[120:121], v[72:73], v[84:85] neg_lo:[0,0,1] neg_hi:[0,0,1]
    v_pk_fma_f32 v[134:135], v[120:121], v[74:75], v[86:87]
    v_cvt_pk_bf16_f32 v94, v112, v114
    v_cvt_pk_bf16_f32 v95, v113, v115
    ds_write_b64 v37, v[94:95] offset:24816
    v_cvt_pk_bf16_f32 v88, v116, v118
    v_cvt_pk_bf16_f32 v89, v117, v119
    ds_write_b64 v37, v[88:89] offset:25344
    v_cvt_pk_bf16_f32 v90, v120, v122
    v_cvt_pk_bf16_f32 v91, v121, v123
    ds_write_b64 v37, v[90:91] offset:25872
    v_pk_mul_f32 v[76:77], v[126:127], v[74:75]
    v_pk_mul_f32 v[78:79], v[126:127], v[72:73]
    v_pk_mul_f32 v[80:81], v[130:131], v[74:75]
    v_pk_mul_f32 v[82:83], v[130:131], v[72:73]
    v_pk_mul_f32 v[84:85], v[134:135], v[74:75]
    v_pk_mul_f32 v[86:87], v[134:135], v[72:73]
    v_pk_fma_f32 v[136:137], v[124:125], v[72:73], v[76:77] neg_lo:[0,0,1] neg_hi:[0,0,1]
    v_pk_fma_f32 v[138:139], v[124:125], v[74:75], v[78:79]
    v_pk_fma_f32 v[140:141], v[128:129], v[72:73], v[80:81] neg_lo:[0,0,1] neg_hi:[0,0,1]
    v_pk_fma_f32 v[142:143], v[128:129], v[74:75], v[82:83]
    v_pk_fma_f32 v[144:145], v[132:133], v[72:73], v[84:85] neg_lo:[0,0,1] neg_hi:[0,0,1]
    v_pk_fma_f32 v[146:147], v[132:133], v[74:75], v[86:87]
    v_cvt_pk_bf16_f32 v92, v124, v126
    v_cvt_pk_bf16_f32 v93, v125, v127
    ds_write_b64 v37, v[92:93] offset:26400
    v_cvt_pk_bf16_f32 v94, v128, v130
    v_cvt_pk_bf16_f32 v95, v129, v131
    ds_write_b64 v37, v[94:95] offset:26928
    v_cvt_pk_bf16_f32 v88, v132, v134
    v_cvt_pk_bf16_f32 v89, v133, v135
    ds_write_b64 v37, v[88:89] offset:27456
    v_pk_mul_f32 v[76:77], v[138:139], v[74:75]
    v_pk_mul_f32 v[78:79], v[138:139], v[72:73]
    v_pk_mul_f32 v[80:81], v[142:143], v[74:75]
    v_pk_mul_f32 v[82:83], v[142:143], v[72:73]
    v_pk_mul_f32 v[84:85], v[146:147], v[74:75]
    v_pk_mul_f32 v[86:87], v[146:147], v[72:73]
    v_pk_fma_f32 v[148:149], v[136:137], v[72:73], v[76:77] neg_lo:[0,0,1] neg_hi:[0,0,1]
    v_pk_fma_f32 v[150:151], v[136:137], v[74:75], v[78:79]
    v_pk_fma_f32 v[152:153], v[140:141], v[72:73], v[80:81] neg_lo:[0,0,1] neg_hi:[0,0,1]
    v_pk_fma_f32 v[154:155], v[140:141], v[74:75], v[82:83]
    v_pk_fma_f32 v[104:105], v[144:145], v[72:73], v[84:85] neg_lo:[0,0,1] neg_hi:[0,0,1]
    v_pk_fma_f32 v[106:107], v[144:145], v[74:75], v[86:87]
    v_cvt_pk_bf16_f32 v90, v136, v138
    v_cvt_pk_bf16_f32 v91, v137, v139
    ds_write_b64 v37, v[90:91] offset:27984
    v_cvt_pk_bf16_f32 v92, v140, v142
    v_cvt_pk_bf16_f32 v93, v141, v143
    ds_write_b64 v37, v[92:93] offset:28512
    v_cvt_pk_bf16_f32 v94, v144, v146
    v_cvt_pk_bf16_f32 v95, v145, v147
    ds_write_b64 v37, v[94:95] offset:29040
    v_pk_mul_f32 v[76:77], v[150:151], v[74:75]
    v_pk_mul_f32 v[78:79], v[150:151], v[72:73]
    v_pk_fma_f32 v[108:109], v[148:149], v[72:73], v[76:77] neg_lo:[0,0,1] neg_hi:[0,0,1]
    v_pk_fma_f32 v[110:111], v[148:149], v[74:75], v[78:79]
    v_cvt_pk_bf16_f32 v88, v148, v150
    v_cvt_pk_bf16_f32 v89, v149, v151
    ds_write_b64 v37, v[88:89] offset:29568
    v_cvt_pk_bf16_f32 v90, v152, v154
    v_cvt_pk_bf16_f32 v91, v153, v155
    ds_write_b64 v37, v[90:91] offset:30096
    v_cvt_pk_bf16_f32 v92, v104, v106
    v_cvt_pk_bf16_f32 v93, v105, v107
    ds_write_b64 v37, v[92:93] offset:30624
    v_cvt_pk_bf16_f32 v94, v108, v110
    v_cvt_pk_bf16_f32 v95, v109, v111
    ds_write_b64 v37, v[94:95] offset:31152
    s_mov_b32 s4, 0x3fb8aa3b
    s_mov_b32 s5, 0x32a57060
    s_mov_b32 s6, 0x3f317218
    s_mov_b32 s7, 0xffff0000
    v_mul_f32 v59, 0x3f800000, v50
    v_mul_f32 v61, 0x3f800000, v51
    v_mul_f32 v58, 0x3f800000, v48
    v_mul_f32 v60, 0x3f800000, v49
    v_fract_f32 v59, v59
    v_fract_f32 v61, v61
    v_exp_f32 v58, v58
    v_exp_f32 v60, v60
    v_cos_f32 v64, v59
    v_cos_f32 v65, v61
    v_sin_f32 v66, v59
    v_sin_f32 v67, v61
    v_mul_f32 v64, v64, v58
    v_mul_f32 v65, v65, v60
    v_mul_f32 v66, v66, v58
    v_mul_f32 v67, v67, v60
    v_mul_f32 v59, 0x43800000, v50
    v_mul_f32 v61, 0x43800000, v51
    v_mul_f32 v58, 0x43800000, v48
    v_mul_f32 v60, 0x43800000, v49
    v_fract_f32 v59, v59
    v_fract_f32 v61, v61
    v_exp_f32 v58, v58
    v_exp_f32 v60, v60
    v_cos_f32 v72, v59
    v_cos_f32 v73, v61
    v_sin_f32 v74, v59
    v_sin_f32 v75, v61
    v_mul_f32 v72, v72, v58
    v_mul_f32 v73, v73, v60
    v_mul_f32 v74, v74, v58
    v_mul_f32 v75, v75, v60
    s_waitcnt vmcnt(0)
    v_lshlrev_b32 v52, 16, v42
    v_and_b32 v53, s7, v42
    v_lshlrev_b32 v54, 16, v43
    v_and_b32 v55, s7, v43
    v_add_f32 v56, v56, v56
    v_mul_f32 v52, v52, v56
    v_mul_f32 v53, v53, v56
    v_mul_f32 v54, v54, v56
    v_mul_f32 v55, v55, v56
    v_cvt_pk_bf16_f32 v88, v52, -v54
    v_cvt_pk_bf16_f32 v89, v53, -v55
    ds_write_b64 v37, v[88:89] offset:0
    v_pk_mul_f32 v[76:77], v[54:55], v[66:67]
    v_pk_mul_f32 v[78:79], v[54:55], v[64:65]
    v_pk_mul_f32 v[80:81], v[54:55], v[70:71]
    v_pk_mul_f32 v[82:83], v[54:55], v[68:69]
    v_pk_mul_f32 v[84:85], v[54:55], v[74:75]
    v_pk_mul_f32 v[86:87], v[54:55], v[72:73]
    v_pk_fma_f32 v[104:105], v[52:53], v[64:65], v[76:77] neg_lo:[0,0,1] neg_hi:[0,0,1]
    v_pk_fma_f32 v[106:107], v[52:53], v[66:67], v[78:79]
    v_pk_fma_f32 v[108:109], v[52:53], v[68:69], v[80:81] neg_lo:[0,0,1] neg_hi:[0,0,1]
    v_pk_fma_f32 v[110:111], v[52:53], v[70:71], v[82:83]
    v_pk_fma_f32 v[112:113], v[52:53], v[72:73], v[84:85] neg_lo:[0,0,1] neg_hi:[0,0,1]
    v_pk_fma_f32 v[114:115], v[52:53], v[74:75], v[86:87]
    v_pk_mul_f32 v[76:77], v[106:107], v[66:67]
    v_pk_mul_f32 v[78:79], v[106:107], v[64:65]
    v_pk_mul_f32 v[80:81], v[110:111], v[74:75]
    v_pk_mul_f32 v[82:83], v[110:111], v[72:73]
    v_pk_fma_f32 v[116:117], v[104:105], v[64:65], v[76:77] neg_lo:[0,0,1] neg_hi:[0,0,1]
    v_pk_fma_f32 v[118:119], v[104:105], v[66:67], v[78:79]
    v_pk_fma_f32 v[120:121], v[108:109], v[72:73], v[80:81] neg_lo:[0,0,1] neg_hi:[0,0,1]
    v_pk_fma_f32 v[122:123], v[108:109], v[74:75], v[82:83]
    v_cvt_pk_bf16_f32 v90, v104, -v106
    v_cvt_pk_bf16_f32 v91, v105, -v107
    ds_write_b64 v37, v[90:91] offset:528
    v_cvt_pk_bf16_f32 v92, v112, -v114
    v_cvt_pk_bf16_f32 v93, v113, -v115
    ds_write_b64 v37, v[92:93] offset:4224
    v_pk_mul_f32 v[76:77], v[118:119], v[66:67]
    v_pk_mul_f32 v[78:79], v[118:119], v[64:65]
    v_pk_mul_f32 v[80:81], v[122:123], v[74:75]
    v_pk_mul_f32 v[82:83], v[122:123], v[72:73]
    v_pk_mul_f32 v[84:85], v[118:119], v[74:75]
    v_pk_mul_f32 v[86:87], v[118:119], v[72:73]
    v_pk_fma_f32 v[124:125], v[116:117], v[64:65], v[76:77] neg_lo:[0,0,1] neg_hi:[0,0,1]
    v_pk_fma_f32 v[126:127], v[116:117], v[66:67], v[78:79]
    v_pk_fma_f32 v[128:129], v[120:121], v[72:73], v[80:81] neg_lo:[0,0,1] neg_hi:[0,0,1]
    v_pk_fma_f32 v[130:131], v[120:121], v[74:75], v[82:83]
    v_pk_fma_f32 v[132:133], v[116:117], v[72:73], v[84:85] neg_lo:[0,0,1] neg_hi:[0,0,1]
    v_pk_fma_f32 v[134:135], v[116:117], v[74:75], v[86:87]
    v_cvt_pk_bf16_f32 v94, v116, -v118
    v_cvt_pk_bf16_f32 v95, v117, -v119
    ds_write_b64 v37, v[94:95] offset:1056
    v_cvt_pk_bf16_f32 v88, v120, -v122
    v_cvt_pk_bf16_f32 v89, v121, -v123
    ds_write_b64 v37, v[88:89] offset:6864
    v_pk_mul_f32 v[76:77], v[126:127], v[66:67]
    v_pk_mul_f32 v[78:79], v[126:127], v[64:65]
    v_pk_mul_f32 v[80:81], v[130:131], v[74:75]
    v_pk_mul_f32 v[82:83], v[130:131], v[72:73]
    v_pk_fma_f32 v[136:137], v[124:125], v[64:65], v[76:77] neg_lo:[0,0,1] neg_hi:[0,0,1]
    v_pk_fma_f32 v[138:139], v[124:125], v[66:67], v[78:79]
    v_pk_fma_f32 v[140:141], v[128:129], v[72:73], v[80:81] neg_lo:[0,0,1] neg_hi:[0,0,1]
    v_pk_fma_f32 v[142:143], v[128:129], v[74:75], v[82:83]
    v_cvt_pk_bf16_f32 v90, v124, -v126
    v_cvt_pk_bf16_f32 v91, v125, -v127
    ds_write_b64 v37, v[90:91] offset:1584
    v_cvt_pk_bf16_f32 v92, v128, -v130
    v_cvt_pk_bf16_f32 v93, v129, -v131
    ds_write_b64 v37, v[92:93] offset:8448
    v_cvt_pk_bf16_f32 v94, v132, -v134
    v_cvt_pk_bf16_f32 v95, v133, -v135
    ds_write_b64 v37, v[94:95] offset:4752
    v_pk_mul_f32 v[76:77], v[138:139], v[66:67]
    v_pk_mul_f32 v[78:79], v[138:139], v[64:65]
    v_pk_mul_f32 v[80:81], v[142:143], v[74:75]
    v_pk_mul_f32 v[82:83], v[142:143], v[72:73]
    v_pk_mul_f32 v[84:85], v[138:139], v[74:75]
    v_pk_mul_f32 v[86:87], v[138:139], v[72:73]
    v_pk_fma_f32 v[144:145], v[136:137], v[64:65], v[76:77] neg_lo:[0,0,1] neg_hi:[0,0,1]
    v_pk_fma_f32 v[146:147], v[136:137], v[66:67], v[78:79]
    v_pk_fma_f32 v[148:149], v[140:141], v[72:73], v[80:81] neg_lo:[0,0,1] neg_hi:[0,0,1]
    v_pk_fma_f32 v[150:151], v[140:141], v[74:75], v[82:83]
    v_pk_fma_f32 v[152:153], v[136:137], v[72:73], v[84:85] neg_lo:[0,0,1] neg_hi:[0,0,1]
    v_pk_fma_f32 v[154:155], v[136:137], v[74:75], v[86:87]
    v_cvt_pk_bf16_f32 v88, v136, -v138
    v_cvt_pk_bf16_f32 v89, v137, -v139
    ds_write_b64 v37, v[88:89] offset:2112
    v_cvt_pk_bf16_f32 v90, v140, -v142
    v_cvt_pk_bf16_f32 v91, v141, -v143
    ds_write_b64 v37, v[90:91] offset:10032
    v_pk_mul_f32 v[76:77], v[146:147], v[66:67]
    v_pk_mul_f32 v[78:79], v[146:147], v[64:65]
    v_pk_mul_f32 v[80:81], v[150:151], v[74:75]
    v_pk_mul_f32 v[82:83], v[150:151], v[72:73]
    v_pk_mul_f32 v[84:85], v[154:155], v[74:75]
    v_pk_mul_f32 v[86:87], v[154:155], v[72:73]
    v_pk_fma_f32 v[104:105], v[144:145], v[64:65], v[76:77] neg_lo:[0,0,1] neg_hi:[0,0,1]
    v_pk_fma_f32 v[106:107], v[144:145], v[66:67], v[78:79]
    v_pk_fma_f32 v[108:109], v[148:149], v[72:73], v[80:81] neg_lo:[0,0,1] neg_hi:[0,0,1]
    v_pk_fma_f32 v[110:111], v[148:149], v[74:75], v[82:83]
    v_pk_fma_f32 v[112:113], v[152:153], v[72:73], v[84:85] neg_lo:[0,0,1] neg_hi:[0,0,1]
    v_pk_fma_f32 v[114:115], v[152:153], v[74:75], v[86:87]
    v_cvt_pk_bf16_f32 v92, v144, -v146
    v_cvt_pk_bf16_f32 v93, v145, -v147
    ds_write_b64 v37, v[92:93] offset:2640
    v_cvt_pk_bf16_f32 v94, v148, -v150
    v_cvt_pk_bf16_f32 v95, v149, -v151
    ds_write_b64 v37, v[94:95] offset:11088
    v_cvt_pk_bf16_f32 v88, v152, -v154
    v_cvt_pk_bf16_f32 v89, v153, -v155
    ds_write_b64 v37, v[88:89] offset:5808
    ds_write_b64 v37, v[88:89] offset:5280
    v_pk_mul_f32 v[76:77], v[106:107], v[66:67]
    v_pk_mul_f32 v[78:79], v[106:107], v[64:65]
    v_pk_mul_f32 v[80:81], v[110:111], v[74:75]
    v_pk_mul_f32 v[82:83], v[110:111], v[72:73]
    v_pk_mul_f32 v[84:85], v[114:115], v[74:75]
    v_pk_mul_f32 v[86:87], v[114:115], v[72:73]
    v_pk_fma_f32 v[116:117], v[104:105], v[64:65], v[76:77] neg_lo:[0,0,1] neg_hi:[0,0,1]
    v_pk_fma_f32 v[118:119], v[104:105], v[66:67], v[78:79]
    v_pk_fma_f32 v[120:121], v[108:109], v[72:73], v[80:81] neg_lo:[0,0,1] neg_hi:[0,0,1]
    v_pk_fma_f32 v[122:123], v[108:109], v[74:75], v[82:83]
    v_pk_fma_f32 v[124:125], v[112:113], v[72:73], v[84:85] neg_lo:[0,0,1] neg_hi:[0,0,1]
    v_pk_fma_f32 v[126:127], v[112:113], v[74:75], v[86:87]
    v_cvt_pk_bf16_f32 v90, v104, -v106
    v_cvt_pk_bf16_f32 v91, v105, -v107
    ds_write_b64 v37, v[90:91] offset:3168
    v_cvt_pk_bf16_f32 v92, v108, -v110
    v_cvt_pk_bf16_f32 v93, v109, -v111
    ds_write_b64 v37, v[92:93] offset:12144
    v_cvt_pk_bf16_f32 v94, v112, -v114
    v_cvt_pk_bf16_f32 v95, v113, -v115
    ds_write_b64 v37, v[94:95] offset:7920
    v_pk_mul_f32 v[76:77], v[106:107], v[74:75]
    v_pk_mul_f32 v[78:79], v[106:107], v[72:73]
    v_pk_mul_f32 v[80:81], v[122:123], v[74:75]
    v_pk_mul_f32 v[82:83], v[122:123], v[72:73]
    v_pk_fma_f32 v[128:129], v[104:105], v[72:73], v[76:77] neg_lo:[0,0,1] neg_hi:[0,0,1]
    v_pk_fma_f32 v[130:131], v[104:105], v[74:75], v[78:79]
    v_pk_fma_f32 v[132:133], v[120:121], v[72:73], v[80:81] neg_lo:[0,0,1] neg_hi:[0,0,1]
    v_pk_fma_f32 v[134:135], v[120:121], v[74:75], v[82:83]
    v_cvt_pk_bf16_f32 v88, v116, -v118
    v_cvt_pk_bf16_f32 v89, v117, -v119
    ds_write_b64 v37, v[88:89] offset:3696
    v_cvt_pk_bf16_f32 v90, v120, -v122
    v_cvt_pk_bf16_f32 v91, v121, -v123
    ds_write_b64 v37, v[90:91] offset:13200
    v_cvt_pk_bf16_f32 v92, v124, -v126
    v_cvt_pk_bf16_f32 v93, v125, -v127
    ds_write_b64 v37, v[92:93] offset:9504
    v_cvt_pk_bf16_f32 v94, v128, -v130
    v_cvt_pk_bf16_f32 v95, v129, -v131
    ds_write_b64 v37, v[94:95] offset:6336
    v_cvt_pk_bf16_f32 v88, v132, -v134
    v_cvt_pk_bf16_f32 v89, v133, -v135
    ds_write_b64 v37, v[88:89] offset:14256
    s_waitcnt lgkmcnt(0)
    ds_read_b128 v[64:67], v18 offset:0
    ds_read_b128 v[68:71], v19 offset:0
    ds_read_b128 v[72:75], v18 offset:32
    ds_read_b128 v[76:79], v19 offset:32
    ds_read_b128 v[80:83], v18 offset:64
    ds_read_b128 v[84:87], v19 offset:64
    ds_read_b128 v[88:91], v18 offset:96
    ds_read_b128 v[92:95], v19 offset:96
    ds_read_b128 v[96:99], v18 offset:128
    ds_read_b128 v[100:103], v19 offset:128
    ds_read_b128 v[104:107], v18 offset:160
    ds_read_b128 v[108:111], v19 offset:160
    s_waitcnt lgkmcnt(10)
    v_mfma_f32_32x32x16_bf16 v[32:47], v[64:67], v[68:71], 0
    ds_read_b128 v[112:115], v18 offset:192
    ds_read_b128 v[116:119], v19 offset:192
    s_waitcnt lgkmcnt(10)
    v_mfma_f32_32x32x16_bf16 v[32:47], v[72:75], v[76:79], v[32:47]
    ds_read_b128 v[120:123], v18 offset:224
    ds_read_b128 v[124:127], v19 offset:224
    s_waitcnt lgkmcnt(10)
    v_mfma_f32_32x32x16_bf16 v[32:47], v[80:83], v[84:87], v[32:47]
    ds_read_b128 v[64:67], v18 offset:256
    ds_read_b128 v[68:71], v19 offset:256
    s_waitcnt lgkmcnt(10)
    v_mfma_f32_32x32x16_bf16 v[32:47], v[88:91], v[92:95], v[32:47]
    ds_read_b128 v[72:75], v18 offset:288
    ds_read_b128 v[76:79], v19 offset:288
    s_waitcnt lgkmcnt(10)
    v_mfma_f32_32x32x16_bf16 v[32:47], v[96:99], v[100:103], v[32:47]
    ds_read_b128 v[80:83], v18 offset:320
    ds_read_b128 v[84:87], v19 offset:320
    s_waitcnt lgkmcnt(10)
    v_mfma_f32_32x32x16_bf16 v[32:47], v[104:107], v[108:111], v[32:47]
    ds_read_b128 v[88:91], v18 offset:352
    ds_read_b128 v[92:95], v19 offset:352
    s_waitcnt lgkmcnt(10)
    v_mfma_f32_32x32x16_bf16 v[32:47], v[112:115], v[116:119], v[32:47]
    ds_read_b128 v[96:99], v18 offset:384
    ds_read_b128 v[100:103], v19 offset:384
    s_waitcnt lgkmcnt(10)
    v_mfma_f32_32x32x16_bf16 v[32:47], v[120:123], v[124:127], v[32:47]
    ds_read_b128 v[104:107], v18 offset:416
    ds_read_b128 v[108:111], v19 offset:416
    s_waitcnt lgkmcnt(10)
    v_mfma_f32_32x32x16_bf16 v[32:47], v[64:67], v[68:71], v[32:47]
    ds_read_b128 v[112:115], v18 offset:448
    ds_read_b128 v[116:119], v19 offset:448
    s_waitcnt lgkmcnt(10)
    v_mfma_f32_32x32x16_bf16 v[32:47], v[72:75], v[76:79], v[32:47]
    ds_read_b128 v[120:123], v18 offset:480
    ds_read_b128 v[124:127], v19 offset:480
    s_waitcnt lgkmcnt(10)
    v_mfma_f32_32x32x16_bf16 v[32:47], v[80:83], v[84:87], v[32:47]
    s_waitcnt lgkmcnt(8)
    v_mfma_f32_32x32x16_bf16 v[32:47], v[88:91], v[92:95], v[32:47]
    s_waitcnt lgkmcnt(6)
    v_mfma_f32_32x32x16_bf16 v[32:47], v[96:99], v[100:103], v[32:47]
    s_waitcnt lgkmcnt(4)
    v_mfma_f32_32x32x16_bf16 v[32:47], v[104:107], v[108:111], v[32:47]
    s_waitcnt lgkmcnt(2)
    v_mfma_f32_32x32x16_bf16 v[32:47], v[112:115], v[116:119], v[32:47]
    s_waitcnt lgkmcnt(0)
    v_mfma_f32_32x32x16_bf16 v[32:47], v[120:123], v[124:127], v[32:47]
    v_mov_b32 v8, 0
    v_mov_b32 v9, 0
    v_mov_b32 v10, 0
    v_mov_b32 v11, 0
    s_mov_b64 exec, 0xffffff
    ds_write_b128 v23, v[8:11] offset:0
    ds_write_b128 v23, v[8:11] offset:4640
    ds_write_b128 v23, v[8:11] offset:9280
    ds_write_b128 v23, v[8:11] offset:13920
    s_mov_b64 exec, 0xff
    ds_write_b128 v23, v[8:11] offset:19712
    ds_write_b128 v23, v[8:11] offset:18560
    ds_write_b128 v23, v[8:11] offset:19840
    ds_write_b128 v23, v[8:11] offset:20224
    ds_write_b128 v23, v[8:11] offset:20608
    ds_write_b128 v23, v[8:11] offset:23872
    ds_write_b128 v23, v[8:11] offset:26976
    ds_write_b128 v23, v[8:11] offset:29072
    s_mov_b64 exec, -1
    s_and_b32 s13, s3, 3
    v_mov_b32 v6, 34928
    v_lshl_add_u32 v6, s13, 2, v6
    v_mov_b32 v7, 1
    s_waitcnt lgkmcnt(0)
    s_mov_b64 exec, 1
    ds_add_u32 v6, v7
    s_mov_b64 exec, -1
    v_lshlrev_b32 v17, 16, v17
    s_mov_b64 exec, 1
    v_add_f32 v32, v32, v17
    s_lshl_b64 exec, 1, 63
    v_cvt_pk_bf16_f32 v132, 0, v38
    v_cvt_pk_bf16_f32 v133, v38, v38
    ds_write_b64 v23, v[132:133] offset:17672
    s_mov_b64 exec, -1
    v_cvt_pk_bf16_f32 v128, v35, v34
    v_cvt_pk_bf16_f32 v129, v33, v32
    ds_write_b64 v20, v[128:129] offset:512
    v_cvt_pk_bf16_f32 v130, v38, v37
    v_cvt_pk_bf16_f32 v131, v36, v36
    ds_write_b64 v20, v[130:131]
    v_cvt_pk_bf16_f32 v134, v42, v41
    ds_write_b32 v21, v134
    v_cvt_pk_bf16_f32 v135, v45, v47
    ds_write_b16 v22, v135 offset:64
    ds_write_b16_d16_hi v22, v135
    v_cvt_pk_bf16_f32 v136, v42, v42
    s_nop 0
    v_readlane_b32 s6, v136, 63
    s_nop 1
    v_mov_b32 v136, s6
    v_cmp_eq_u32 vcc, 0, v5
    s_nop 1
    v_cndmask_b32 v160, 0, v136, vcc
    v_cmp_eq_u32 vcc, 1, v5
    s_nop 1
    v_cndmask_b32 v161, 0, v136, vcc
    v_cmp_eq_u32 vcc, 2, v5
    s_nop 1
    v_cndmask_b32 v162, 0, v136, vcc
    v_cmp_eq_u32 vcc, 3, v5
    s_nop 1
    v_cndmask_b32 v163, 0, v136, vcc
    s_waitcnt lgkmcnt(0)
    v_mov_b32 v32, 0
    v_mov_b32 v33, 0
    v_mov_b32 v34, 0
    v_mov_b32 v35, 0
    v_mov_b32 v36, 0
    v_mov_b32 v37, 0
    v_mov_b32 v38, 0
    v_mov_b32 v39, 0
    v_mov_b32 v40, 0
    v_mov_b32 v41, 0
    v_mov_b32 v42, 0
    v_mov_b32 v43, 0
    v_mov_b32 v44, 0
    v_mov_b32 v45, 0
    v_mov_b32 v46, 0
    v_mov_b32 v47, 0
    v_mov_b32 v48, 0
    v_mov_b32 v49, 0
    v_mov_b32 v50, 0
    v_mov_b32 v51, 0
    v_mov_b32 v52, 0
    v_mov_b32 v53, 0
    v_mov_b32 v54, 0
    v_mov_b32 v55, 0
    v_mov_b32 v56, 0
    v_mov_b32 v57, 0
    v_mov_b32 v58, 0
    v_mov_b32 v59, 0
    v_mov_b32 v60, 0
    v_mov_b32 v61, 0
    v_mov_b32 v62, 0
    v_mov_b32 v63, 0
    v_mov_b32 v128, 0
    v_mov_b32 v129, 0
    s_add_u32 s44, s40, 0x800000
    s_addc_u32 s45, s41, 0
    s_and_b32 s45, s45, 0xffff
    s_mov_b32 s46, 0x420000
    s_mov_b32 s47, 0x00020000
    v_mov_b32 v8, 34868
.spin_40:
    ds_read_b32 v9, v8
    s_waitcnt lgkmcnt(0)
    v_readfirstlane_b32 s14, v9
    s_nop 1
    s_cmp_ge_u32 s14, 1
    s_cbranch_scc1 .spun_41
    s_sleep 1
    s_branch .spin_40
.spun_41:
    s_and_b32 s14, s14, 0xfcfcfcd8
    s_or_b32 s14, s14, 0x18
    v_and_b32 v8, 3, v2
    v_lshlrev_b32 v8, 3, v8
    v_lshrrev_b32 v8, v8, s14
    v_and_b32 v9, 12, v8
    v_lshlrev_b32 v12, 6, v9
    v_and_b32 v9, 0x30, v8
    v_lshl_or_b32 v12, v9, 12, v12
    v_and_b32 v9, 0xc0, v8
    v_lshl_or_b32 v12, v9, 18, v12
    s_mov_b32 s60, 0x06040200
    s_mov_b32 s61, 0x01010101
    s_mov_b32 s62, 0x03030303
    s_mov_b32 s63, 524288
    s_mov_b64 s[52:53], -1
    s_mov_b64 s[54:55], -1
    s_mov_b64 s[56:57], -1
    s_mov_b64 s[58:59], -1
    s_setprio 3
.a_poll:
    s_mov_b64 exec, s[52:53]
    buffer_load_dwordx4 v[130:133], v3, s[44:47], s15 offen offset:0 sc1
    s_mov_b64 exec, s[54:55]
    buffer_load_dwordx4 v[138:141], v3, s[44:47], s15 offen offset:1024 sc1
    s_mov_b64 exec, s[56:57]
    buffer_load_dwordx4 v[146:149], v3, s[44:47], s15 offen offset:2048 sc1
    s_mov_b64 exec, s[58:59]
    buffer_load_dwordx4 v[154:157], v3, s[44:47], s15 offen offset:3072 sc1
.a_chk:
    s_waitcnt vmcnt(0)
    s_mov_b64 exec, s[52:53]
    v_perm_b32 v8, v131, v130, s60
    v_perm_b32 v9, v133, v132, s60
    v_lshlrev_b32 v9, 1, v9
    v_bfi_b32 v8, s61, v8, v9
    v_and_b32 v8, s62, v8
    v_cmp_ne_u32 s[52:53], v8, v12
    s_mov_b64 exec, s[54:55]
    v_perm_b32 v8, v139, v138, s60
    v_perm_b32 v9, v141, v140, s60
    v_lshlrev_b32 v9, 1, v9
    v_bfi_b32 v8, s61, v8, v9
    v_and_b32 v8, s62, v8
    v_cmp_ne_u32 s[54:55], v8, v12
    s_mov_b64 exec, s[56:57]
    v_perm_b32 v8, v147, v146, s60
    v_perm_b32 v9, v149, v148, s60
    v_lshlrev_b32 v9, 1, v9
    v_bfi_b32 v8, s61, v8, v9
    v_and_b32 v8, s62, v8
    v_cmp_ne_u32 s[56:57], v8, v12
    s_mov_b64 exec, s[58:59]
    v_perm_b32 v8, v155, v154, s60
    v_perm_b32 v9, v157, v156, s60
    v_lshlrev_b32 v9, 1, v9
    v_bfi_b32 v8, s61, v8, v9
    v_and_b32 v8, s62, v8
    v_cmp_ne_u32 s[58:59], v8, v12
    s_wqm_b64 s[52:53], s[52:53]
    s_wqm_b64 s[54:55], s[54:55]
    s_wqm_b64 s[56:57], s[56:57]
    s_wqm_b64 s[58:59], s[58:59]
    s_or_b64 s[4:5], s[52:53], s[54:55]
    s_or_b64 vcc, s[56:57], s[58:59]
    s_or_b64 s[4:5], s[4:5], vcc
    s_cbranch_scc0 .a_got
    s_sub_u32 s63, s63, 1
    s_cmp_lg_u32 s63, 0
    s_cbranch_scc1 .a_poll
.a_got:
    s_mov_b64 exec, -1
    s_mov_b32 s60, 0xfffefffe
    v_mov_b32 v12, 0x10000
    v_mov_b32 v8, 34856
    v_mov_b32 v9, 1
    s_waitcnt lgkmcnt(0)
    s_mov_b64 exec, 1
    ds_add_u32 v8, v9
    s_mov_b64 exec, -1
    s_waitcnt vmcnt(3)
    v_and_or_b32 v130, v130, s60, v12
    v_and_or_b32 v131, v131, s60, v12
    v_and_or_b32 v132, v132, s60, v12
    v_and_or_b32 v133, v133, s60, v12
    ds_write_b128 v23, v[130:133] offset:14304
    v_mov_b32_dpp v128, v132 wave_shr:1 row_mask:0xf bank_mask:0xf
    v_mov_b32_dpp v129, v133 wave_shr:1 row_mask:0xf bank_mask:0xf
    v_mov_b32_dpp v136, v132 wave_ror:1 row_mask:0xf bank_mask:0xf
    v_mov_b32_dpp v137, v133 wave_ror:1 row_mask:0xf bank_mask:0xf
    v_mov_b32 v72, v129
    v_mov_b32 v73, v130
    v_mov_b32 v74, v131
    v_mov_b32 v75, v132
    ds_write_b128 v23, v[72:75] offset:5024
    v_alignbit_b32 v64, v129, v128, 16
    v_alignbit_b32 v65, v130, v129, 16
    v_alignbit_b32 v66, v131, v130, 16
    v_alignbit_b32 v67, v132, v131, 16
    ds_write_b128 v23, v[64:67] offset:384
    v_mov_b32 v68, v65
    v_mov_b32 v69, v66
    v_mov_b32 v70, v67
    v_alignbit_b32 v71, v133, v132, 16
    ds_write_b128 v23, v[68:71] offset:9664
    s_waitcnt vmcnt(2)
    v_and_or_b32 v138, v138, s60, v12
    v_and_or_b32 v139, v139, s60, v12
    v_and_or_b32 v140, v140, s60, v12
    v_and_or_b32 v141, v141, s60, v12
    ds_write_b128 v23, v[138:141] offset:15328
    v_mov_b32_dpp v136, v140 wave_shr:1 row_mask:0xf bank_mask:0xf
    v_mov_b32_dpp v137, v141 wave_shr:1 row_mask:0xf bank_mask:0xf
    v_mov_b32_dpp v144, v140 wave_ror:1 row_mask:0xf bank_mask:0xf
    v_mov_b32_dpp v145, v141 wave_ror:1 row_mask:0xf bank_mask:0xf
    v_mov_b32 v84, v137
    v_mov_b32 v85, v138
    v_mov_b32 v86, v139
    v_mov_b32 v87, v140
    ds_write_b128 v23, v[84:87] offset:6048
    v_alignbit_b32 v76, v137, v136, 16
    v_alignbit_b32 v77, v138, v137, 16
    v_alignbit_b32 v78, v139, v138, 16
    v_alignbit_b32 v79, v140, v139, 16
    ds_write_b128 v23, v[76:79] offset:1408
    v_mov_b32 v80, v77
    v_mov_b32 v81, v78
    v_mov_b32 v82, v79
    v_alignbit_b32 v83, v141, v140, 16
    ds_write_b128 v23, v[80:83] offset:10688
    s_waitcnt vmcnt(1)
    v_and_or_b32 v146, v146, s60, v12
    v_and_or_b32 v147, v147, s60, v12
    v_and_or_b32 v148, v148, s60, v12
    v_and_or_b32 v149, v149, s60, v12
    ds_write_b128 v23, v[146:149] offset:16352
    v_mov_b32_dpp v144, v148 wave_shr:1 row_mask:0xf bank_mask:0xf
    v_mov_b32_dpp v145, v149 wave_shr:1 row_mask:0xf bank_mask:0xf
    v_mov_b32_dpp v152, v148 wave_ror:1 row_mask:0xf bank_mask:0xf
    v_mov_b32_dpp v153, v149 wave_ror:1 row_mask:0xf bank_mask:0xf
    v_mov_b32 v96, v145
    v_mov_b32 v97, v146
    v_mov_b32 v98, v147
    v_mov_b32 v99, v148
    ds_write_b128 v23, v[96:99] offset:7072
    v_alignbit_b32 v88, v145, v144, 16
    v_alignbit_b32 v89, v146, v145, 16
    v_alignbit_b32 v90, v147, v146, 16
    v_alignbit_b32 v91, v148, v147, 16
    ds_write_b128 v23, v[88:91] offset:2432
    v_mov_b32 v92, v89
    v_mov_b32 v93, v90
    v_mov_b32 v94, v91
    v_alignbit_b32 v95, v149, v148, 16
    ds_write_b128 v23, v[92:95] offset:11712
    s_waitcnt vmcnt(0)
    v_and_or_b32 v154, v154, s60, v12
    v_and_or_b32 v155, v155, s60, v12
    v_and_or_b32 v156, v156, s60, v12
    v_and_or_b32 v157, v157, s60, v12
    ds_write_b128 v23, v[154:157] offset:17376
    v_mov_b32_dpp v152, v156 wave_shr:1 row_mask:0xf bank_mask:0xf
    v_mov_b32_dpp v153, v157 wave_shr:1 row_mask:0xf bank_mask:0xf
    v_mov_b32 v108, v153
    v_mov_b32 v109, v154
    v_mov_b32 v110, v155
    v_mov_b32 v111, v156
    ds_write_b128 v23, v[108:111] offset:8096
    v_alignbit_b32 v100, v153, v152, 16
    v_alignbit_b32 v101, v154, v153, 16
    v_alignbit_b32 v102, v155, v154, 16
    v_alignbit_b32 v103, v156, v155, 16
    ds_write_b128 v23, v[100:103] offset:3456
    v_mov_b32 v104, v101
    v_mov_b32 v105, v102
    v_mov_b32 v106, v103
    v_alignbit_b32 v107, v157, v156, 16
    ds_write_b128 v23, v[104:107] offset:12736
    s_and_b32 s13, s3, 3
    v_mov_b32 v8, 34904
    v_lshl_add_u32 v8, s13, 2, v8
    v_mov_b32 v9, 1
    s_waitcnt lgkmcnt(0)
    s_mov_b64 exec, 1
    ds_add_u32 v8, v9
    s_mov_b64 exec, -1
    s_setprio 1
    ds_read_b128 v[64:67], v25 offset:3584
    ds_read_b64 v[68:69], v24 offset:3584
    ds_read_b64 v[70:71], v24 offset:3592
    ds_read_b128 v[72:75], v25 offset:3072
    ds_read_b64 v[76:77], v24 offset:3072
    ds_read_b64 v[78:79], v24 offset:3080
    ds_read_b128 v[80:83], v25 offset:2560
    ds_read_b128 v[84:87], v25 offset:2048
    ds_read_b128 v[88:91], v25 offset:1536
    ds_read_b128 v[92:95], v25 offset:1024
    ds_read_b128 v[96:99], v25 offset:512
    ds_read_b128 v[100:103], v25 offset:0
    ds_read_b128 v[104:107], v25 offset:3648
    s_waitcnt lgkmcnt(10)
    v_mfma_f32_16x16x32_bf16 v[60:63], v[64:67], v[68:71], v[60:63]
    ds_read_b64 v[108:109], v24 offset:3648
    ds_read_b64 v[110:111], v24 offset:3656
    ds_read_b128 v[112:115], v25 offset:3136
    s_waitcnt lgkmcnt(12)
    v_mfma_f32_16x16x32_bf16 v[56:59], v[72:75], v[68:71], v[56:59]
    ds_read_b64 v[116:117], v24 offset:3136
    ds_read_b64 v[118:119], v24 offset:3144
    s_waitcnt lgkmcnt(12)
    v_mfma_f32_16x16x32_bf16 v[60:63], v[72:75], v[76:79], v[60:63]
    ds_read_b128 v[120:123], v25 offset:2624
    s_waitcnt lgkmcnt(12)
    v_mfma_f32_16x16x32_bf16 v[52:55], v[80:83], v[68:71], v[52:55]
    ds_read_b128 v[124:127], v25 offset:2112
    v_mfma_f32_16x16x32_bf16 v[56:59], v[80:83], v[76:79], v[56:59]
    s_waitcnt lgkmcnt(12)
    v_mfma_f32_16x16x32_bf16 v[48:51], v[84:87], v[68:71], v[48:51]
    ds_read_b128 v[152:155], v25 offset:1600
    v_mfma_f32_16x16x32_bf16 v[52:55], v[84:87], v[76:79], v[52:55]
    s_waitcnt lgkmcnt(12)
    v_mfma_f32_16x16x32_bf16 v[44:47], v[88:91], v[68:71], v[44:47]
    ds_read_b128 v[156:159], v25 offset:1088
    v_mfma_f32_16x16x32_bf16 v[48:51], v[88:91], v[76:79], v[48:51]
    s_waitcnt lgkmcnt(12)
    v_mfma_f32_16x16x32_bf16 v[40:43], v[92:95], v[68:71], v[40:43]
    ds_read_b128 v[164:167], v25 offset:576
    v_mfma_f32_16x16x32_bf16 v[44:47], v[92:95], v[76:79], v[44:47]
    s_waitcnt lgkmcnt(12)
    v_mfma_f32_16x16x32_bf16 v[36:39], v[96:99], v[68:71], v[36:39]
    ds_read_b128 v[64:67], v25 offset:64
    v_mfma_f32_16x16x32_bf16 v[40:43], v[96:99], v[76:79], v[40:43]
    s_waitcnt lgkmcnt(12)
    v_mfma_f32_16x16x32_bf16 v[32:35], v[100:103], v[68:71], v[32:35]
    ds_read_b128 v[72:75], v25 offset:3712
    v_mfma_f32_16x16x32_bf16 v[36:39], v[100:103], v[76:79], v[36:39]
    s_waitcnt lgkmcnt(10)
    v_mfma_f32_16x16x32_bf16 v[60:63], v[104:107], v[108:111], v[60:63]
    ds_read_b64 v[80:81], v24 offset:3712
    ds_read_b64 v[82:83], v24 offset:3720
    ds_read_b128 v[84:87], v25 offset:3200
    s_waitcnt lgkmcnt(12)
    v_mfma_f32_16x16x32_bf16 v[56:59], v[112:115], v[108:111], v[56:59]
    ds_read_b64 v[88:89], v24 offset:3200
    ds_read_b64 v[90:91], v24 offset:3208
    s_waitcnt lgkmcnt(12)
    v_mfma_f32_16x16x32_bf16 v[60:63], v[112:115], v[116:119], v[60:63]
    ds_read_b128 v[92:95], v25 offset:2688
    s_waitcnt lgkmcnt(12)
    v_mfma_f32_16x16x32_bf16 v[52:55], v[120:123], v[108:111], v[52:55]
    ds_read_b128 v[96:99], v25 offset:2176
    v_mfma_f32_16x16x32_bf16 v[56:59], v[120:123], v[116:119], v[56:59]
    s_waitcnt lgkmcnt(12)
    v_mfma_f32_16x16x32_bf16 v[48:51], v[124:127], v[108:111], v[48:51]
    ds_read_b128 v[68:71], v25 offset:1664
    v_mfma_f32_16x16x32_bf16 v[52:55], v[124:127], v[116:119], v[52:55]
    s_waitcnt lgkmcnt(12)
    v_mfma_f32_16x16x32_bf16 v[44:47], v[152:155], v[108:111], v[44:47]
    ds_read_b128 v[100:103], v25 offset:1152
    v_mfma_f32_16x16x32_bf16 v[48:51], v[152:155], v[116:119], v[48:51]
    s_waitcnt lgkmcnt(12)
    v_mfma_f32_16x16x32_bf16 v[40:43], v[156:159], v[108:111], v[40:43]
    ds_read_b128 v[76:79], v25 offset:640
    v_mfma_f32_16x16x32_bf16 v[44:47], v[156:159], v[116:119], v[44:47]
    s_waitcnt lgkmcnt(12)
    v_mfma_f32_16x16x32_bf16 v[36:39], v[164:167], v[108:111], v[36:39]
    ds_read_b128 v[104:107], v25 offset:128
    v_mfma_f32_16x16x32_bf16 v[40:43], v[164:167], v[116:119], v[40:43]
    s_waitcnt lgkmcnt(12)
    v_mfma_f32_16x16x32_bf16 v[32:35], v[64:67], v[108:111], v[32:35]
    ds_read_b128 v[112:115], v25 offset:3776
    v_mfma_f32_16x16x32_bf16 v[36:39], v[64:67], v[116:119], v[36:39]
    s_waitcnt lgkmcnt(10)
    v_mfma_f32_16x16x32_bf16 v[60:63], v[72:75], v[80:83], v[60:63]
    ds_read_b64 v[120:121], v24 offset:3776
    ds_read_b64 v[122:123], v24 offset:3784
    ds_read_b128 v[124:127], v25 offset:3264
    s_waitcnt lgkmcnt(12)
    v_mfma_f32_16x16x32_bf16 v[56:59], v[84:87], v[80:83], v[56:59]
    ds_read_b64 v[152:153], v24 offset:3264
    ds_read_b64 v[154:155], v24 offset:3272
    s_waitcnt lgkmcnt(12)
    v_mfma_f32_16x16x32_bf16 v[60:63], v[84:87], v[88:91], v[60:63]
    ds_read_b128 v[156:159], v25 offset:2752
    s_waitcnt lgkmcnt(12)
    v_mfma_f32_16x16x32_bf16 v[52:55], v[92:95], v[80:83], v[52:55]
    ds_read_b128 v[164:167], v25 offset:2240
    v_mfma_f32_16x16x32_bf16 v[56:59], v[92:95], v[88:91], v[56:59]
    s_waitcnt lgkmcnt(12)
    v_mfma_f32_16x16x32_bf16 v[48:51], v[96:99], v[80:83], v[48:51]
    ds_read_b128 v[108:111], v25 offset:1728
    v_mfma_f32_16x16x32_bf16 v[52:55], v[96:99], v[88:91], v[52:55]
    s_waitcnt lgkmcnt(12)
    v_mfma_f32_16x16x32_bf16 v[44:47], v[68:71], v[80:83], v[44:47]
    ds_read_b128 v[64:67], v25 offset:1216
    v_mfma_f32_16x16x32_bf16 v[48:51], v[68:71], v[88:91], v[48:51]
    s_waitcnt lgkmcnt(12)
    v_mfma_f32_16x16x32_bf16 v[40:43], v[100:103], v[80:83], v[40:43]
    ds_read_b128 v[116:119], v25 offset:704
    v_mfma_f32_16x16x32_bf16 v[44:47], v[100:103], v[88:91], v[44:47]
    s_waitcnt lgkmcnt(12)
    v_mfma_f32_16x16x32_bf16 v[36:39], v[76:79], v[80:83], v[36:39]
    ds_read_b128 v[72:75], v25 offset:192
    v_mfma_f32_16x16x32_bf16 v[40:43], v[76:79], v[88:91], v[40:43]
    s_waitcnt lgkmcnt(12)
    v_mfma_f32_16x16x32_bf16 v[32:35], v[104:107], v[80:83], v[32:35]
    ds_read_b128 v[84:87], v25 offset:3840
    v_mfma_f32_16x16x32_bf16 v[36:39], v[104:107], v[88:91], v[36:39]
    s_waitcnt lgkmcnt(10)
    v_mfma_f32_16x16x32_bf16 v[60:63], v[112:115], v[120:123], v[60:63]
    ds_read_b64 v[92:93], v24 offset:3840
    ds_read_b64 v[94:95], v24 offset:3848
    ds_read_b128 v[96:99], v25 offset:3328
    s_waitcnt lgkmcnt(12)
    v_mfma_f32_16x16x32_bf16 v[56:59], v[124:127], v[120:123], v[56:59]
    ds_read_b64 v[68:69], v24 offset:3328
    ds_read_b64 v[70:71], v24 offset:3336
    s_waitcnt lgkmcnt(12)
    v_mfma_f32_16x16x32_bf16 v[60:63], v[124:127], v[152:155], v[60:63]
    ds_read_b128 v[100:103], v25 offset:2816
    s_waitcnt lgkmcnt(12)
    v_mfma_f32_16x16x32_bf16 v[52:55], v[156:159], v[120:123], v[52:55]
    ds_read_b128 v[76:79], v25 offset:2304
    v_mfma_f32_16x16x32_bf16 v[56:59], v[156:159], v[152:155], v[56:59]
    s_waitcnt lgkmcnt(12)
    v_mfma_f32_16x16x32_bf16 v[48:51], v[164:167], v[120:123], v[48:51]
    ds_read_b128 v[80:83], v25 offset:1792
    v_mfma_f32_16x16x32_bf16 v[52:55], v[164:167], v[152:155], v[52:55]
    s_waitcnt lgkmcnt(12)
    v_mfma_f32_16x16x32_bf16 v[44:47], v[108:111], v[120:123], v[44:47]
    ds_read_b128 v[104:107], v25 offset:1280
    v_mfma_f32_16x16x32_bf16 v[48:51], v[108:111], v[152:155], v[48:51]
    s_waitcnt lgkmcnt(12)
    v_mfma_f32_16x16x32_bf16 v[40:43], v[64:67], v[120:123], v[40:43]
    ds_read_b128 v[88:91], v25 offset:768
    v_mfma_f32_16x16x32_bf16 v[44:47], v[64:67], v[152:155], v[44:47]
    s_waitcnt lgkmcnt(12)
    v_mfma_f32_16x16x32_bf16 v[36:39], v[116:119], v[120:123], v[36:39]
    ds_read_b128 v[112:115], v25 offset:256
    v_mfma_f32_16x16x32_bf16 v[40:43], v[116:119], v[152:155], v[40:43]
    s_waitcnt lgkmcnt(12)
    v_mfma_f32_16x16x32_bf16 v[32:35], v[72:75], v[120:123], v[32:35]
    ds_read_b128 v[124:127], v25 offset:3904
    v_mfma_f32_16x16x32_bf16 v[36:39], v[72:75], v[152:155], v[36:39]
    s_waitcnt lgkmcnt(10)
    v_mfma_f32_16x16x32_bf16 v[60:63], v[84:87], v[92:95], v[60:63]
    ds_read_b64 v[156:157], v24 offset:3904
    ds_read_b64 v[158:159], v24 offset:3912
    ds_read_b128 v[164:167], v25 offset:3392
    s_waitcnt lgkmcnt(12)
    v_mfma_f32_16x16x32_bf16 v[56:59], v[96:99], v[92:95], v[56:59]
    ds_read_b64 v[108:109], v24 offset:3392
    ds_read_b64 v[110:111], v24 offset:3400
    s_waitcnt lgkmcnt(12)
    v_mfma_f32_16x16x32_bf16 v[60:63], v[96:99], v[68:71], v[60:63]
    ds_read_b128 v[64:67], v25 offset:2880
    s_waitcnt lgkmcnt(12)
    v_mfma_f32_16x16x32_bf16 v[52:55], v[100:103], v[92:95], v[52:55]
    ds_read_b128 v[116:119], v25 offset:2368
    v_mfma_f32_16x16x32_bf16 v[56:59], v[100:103], v[68:71], v[56:59]
    s_waitcnt lgkmcnt(12)
    v_mfma_f32_16x16x32_bf16 v[48:51], v[76:79], v[92:95], v[48:51]
    ds_read_b128 v[120:123], v25 offset:1856
    v_mfma_f32_16x16x32_bf16 v[52:55], v[76:79], v[68:71], v[52:55]
    s_waitcnt lgkmcnt(12)
    v_mfma_f32_16x16x32_bf16 v[44:47], v[80:83], v[92:95], v[44:47]
    ds_read_b128 v[72:75], v25 offset:1344
    v_mfma_f32_16x16x32_bf16 v[48:51], v[80:83], v[68:71], v[48:51]
    s_waitcnt lgkmcnt(12)
    v_mfma_f32_16x16x32_bf16 v[40:43], v[104:107], v[92:95], v[40:43]
    ds_read_b128 v[152:155], v25 offset:832
    v_mfma_f32_16x16x32_bf16 v[44:47], v[104:107], v[68:71], v[44:47]
    s_waitcnt lgkmcnt(12)
    v_mfma_f32_16x16x32_bf16 v[36:39], v[88:91], v[92:95], v[36:39]
    ds_read_b128 v[84:87], v25 offset:320
    v_mfma_f32_16x16x32_bf16 v[40:43], v[88:91], v[68:71], v[40:43]
    s_waitcnt lgkmcnt(12)
    v_mfma_f32_16x16x32_bf16 v[32:35], v[112:115], v[92:95], v[32:35]
    ds_read_b64_tr_b16 v[96:97], v15 offset:0
    ds_read_b64_tr_b16 v[98:99], v15 offset:64
    v_mfma_f32_16x16x32_bf16 v[36:39], v[112:115], v[68:71], v[36:39]
    s_waitcnt lgkmcnt(11)
    v_mfma_f32_16x16x32_bf16 v[60:63], v[124:127], v[156:159], v[60:63]
    ds_read_b64_tr_b16 v[100:101], v15 offset:512
    ds_read_b64_tr_b16 v[102:103], v15 offset:576
    s_waitcnt lgkmcnt(12)
    v_mfma_f32_16x16x32_bf16 v[56:59], v[164:167], v[156:159], v[56:59]
    ds_read_b64_tr_b16 v[76:77], v15 offset:1024
    ds_read_b64_tr_b16 v[78:79], v15 offset:1088
    s_waitcnt lgkmcnt(12)
    v_mfma_f32_16x16x32_bf16 v[60:63], v[164:167], v[108:111], v[60:63]
    ds_read_b64_tr_b16 v[80:81], v15 offset:1536
    ds_read_b64_tr_b16 v[82:83], v15 offset:1600
    s_waitcnt lgkmcnt(13)
    v_mfma_f32_16x16x32_bf16 v[52:55], v[64:67], v[156:159], v[52:55]
    v_mfma_f32_16x16x32_bf16 v[56:59], v[64:67], v[108:111], v[56:59]
    s_waitcnt lgkmcnt(12)
    v_mfma_f32_16x16x32_bf16 v[48:51], v[116:119], v[156:159], v[48:51]
    v_mfma_f32_16x16x32_bf16 v[52:55], v[116:119], v[108:111], v[52:55]
    s_waitcnt lgkmcnt(11)
    v_mfma_f32_16x16x32_bf16 v[44:47], v[120:123], v[156:159], v[44:47]
    v_mfma_f32_16x16x32_bf16 v[48:51], v[120:123], v[108:111], v[48:51]
    s_waitcnt lgkmcnt(10)
    v_mfma_f32_16x16x32_bf16 v[40:43], v[72:75], v[156:159], v[40:43]
    v_mfma_f32_16x16x32_bf16 v[44:47], v[72:75], v[108:111], v[44:47]
    s_waitcnt lgkmcnt(9)
    v_mfma_f32_16x16x32_bf16 v[36:39], v[152:155], v[156:159], v[36:39]
    v_mfma_f32_16x16x32_bf16 v[40:43], v[152:155], v[108:111], v[40:43]
    s_waitcnt lgkmcnt(8)
    v_mfma_f32_16x16x32_bf16 v[32:35], v[84:87], v[156:159], v[32:35]
    v_mfma_f32_16x16x32_bf16 v[36:39], v[84:87], v[108:111], v[36:39]
    s_waitcnt lgkmcnt(6)
    v_mfma_f32_16x16x32_bf16 v[136:139], v[96:99], v[160:163], 0
    s_waitcnt lgkmcnt(4)
    v_mfma_f32_16x16x32_bf16 v[140:143], v[100:103], v[160:163], 0
    s_waitcnt lgkmcnt(2)
    v_mfma_f32_16x16x32_bf16 v[144:147], v[76:79], v[160:163], 0
    s_waitcnt lgkmcnt(0)
    v_mfma_f32_16x16x32_bf16 v[148:151], v[80:83], v[160:163], 0
    v_mov_b32 v8, 34888
    v_lshl_add_u32 v8, s13, 2, v8
.spin_42:
    ds_read_b32 v9, v8
    s_waitcnt lgkmcnt(0)
    v_readfirstlane_b32 s4, v9
    s_nop 1
    s_cmp_ge_u32 s4, 1
    s_cbranch_scc1 .spun_43
    s_sleep 1
    s_branch .spin_42
.spun_43:
    ds_read_b64_tr_b16 v[104:105], v13 offset:0
    ds_read_b64_tr_b16 v[106:107], v13 offset:32
    ds_read_b64 v[88:89], v24 offset:4480
    ds_read_b64 v[90:91], v24 offset:4488
    ds_read_b64 v[92:93], v24 offset:4352
    ds_read_b64 v[94:95], v24 offset:4360
    ds_read_b64 v[112:113], v24 offset:4224
    ds_read_b64 v[114:115], v24 offset:4232
    ds_read_b64_tr_b16 v[68:69], v13 offset:256
    ds_read_b64_tr_b16 v[70:71], v13 offset:288
    ds_read_b64 v[124:125], v24 offset:4544
    ds_read_b64 v[126:127], v24 offset:4552
    ds_read_b64 v[164:165], v24 offset:4416
    ds_read_b64 v[166:167], v24 offset:4424
    s_waitcnt lgkmcnt(10)
    v_mfma_f32_16x16x32_bf16 v[128:131], v[104:107], v[88:91], 0
    ds_read_b64 v[64:65], v24 offset:4288
    ds_read_b64 v[66:67], v24 offset:4296
    ds_read_b64_tr_b16 v[116:117], v13 offset:512
    ds_read_b64_tr_b16 v[118:119], v13 offset:544
    s_waitcnt lgkmcnt(12)
    v_mfma_f32_16x16x32_bf16 v[132:135], v[104:107], v[92:95], 0
    ds_read_b64_tr_b16 v[120:121], v13 offset:768
    ds_read_b64_tr_b16 v[122:123], v13 offset:800
    s_waitcnt lgkmcnt(12)
    v_mfma_f32_16x16x32_bf16 v[136:139], v[104:107], v[112:115], v[136:139]
    ds_read_b64_tr_b16 v[72:73], v13 offset:1024
    ds_read_b64_tr_b16 v[74:75], v13 offset:1056
    s_waitcnt lgkmcnt(10)
    v_mfma_f32_16x16x32_bf16 v[128:131], v[68:71], v[124:127], v[128:131]
    ds_read_b64_tr_b16 v[152:153], v13 offset:1280
    ds_read_b64_tr_b16 v[154:155], v13 offset:1312
    ds_read_b64_tr_b16 v[156:157], v13 offset:1536
    ds_read_b64_tr_b16 v[158:159], v13 offset:1568
    s_waitcnt lgkmcnt(12)
    v_mfma_f32_16x16x32_bf16 v[132:135], v[68:71], v[164:167], v[132:135]
    ds_read_b64_tr_b16 v[84:85], v13 offset:1792
    ds_read_b64_tr_b16 v[86:87], v13 offset:1824
    s_waitcnt lgkmcnt(12)
    v_mfma_f32_16x16x32_bf16 v[136:139], v[68:71], v[64:67], v[136:139]
    ds_read_b64_tr_b16 v[108:109], v14 offset:0
    ds_read_b64_tr_b16 v[110:111], v14 offset:64
    s_waitcnt lgkmcnt(12)
    v_mfma_f32_16x16x32_bf16 v[140:143], v[116:119], v[112:115], v[140:143]
    ds_read2_b32 v[96:97], v16 offset0:32 offset1:33
    ds_read2_b32 v[98:99], v16 offset0:34 offset1:35
    v_mfma_f32_16x16x32_bf16 v[132:135], v[116:119], v[88:91], v[132:135]
    v_mfma_f32_16x16x32_bf16 v[136:139], v[116:119], v[92:95], v[136:139]
    s_waitcnt lgkmcnt(12)
    v_mfma_f32_16x16x32_bf16 v[140:143], v[120:123], v[64:67], v[140:143]
    ds_read_b64_tr_b16 v[100:101], v13 offset:2048
    ds_read_b64_tr_b16 v[102:103], v13 offset:2080
    v_mfma_f32_16x16x32_bf16 v[132:135], v[120:123], v[124:127], v[132:135]
    v_mfma_f32_16x16x32_bf16 v[136:139], v[120:123], v[164:167], v[136:139]
    s_waitcnt lgkmcnt(12)
    v_mfma_f32_16x16x32_bf16 v[140:143], v[72:75], v[92:95], v[140:143]
    ds_read2_b32 v[76:77], v16 offset0:48 offset1:49
    ds_read2_b32 v[78:79], v16 offset0:50 offset1:51
    v_mfma_f32_16x16x32_bf16 v[144:147], v[72:75], v[112:115], v[144:147]
    v_mfma_f32_16x16x32_bf16 v[136:139], v[72:75], v[88:91], v[136:139]
    s_waitcnt lgkmcnt(12)
    v_mfma_f32_16x16x32_bf16 v[140:143], v[152:155], v[164:167], v[140:143]
    ds_read_b64_tr_b16 v[80:81], v13 offset:2304
    ds_read_b64_tr_b16 v[82:83], v13 offset:2336
    v_mfma_f32_16x16x32_bf16 v[144:147], v[152:155], v[64:67], v[144:147]
    v_mfma_f32_16x16x32_bf16 v[136:139], v[152:155], v[124:127], v[136:139]
    s_waitcnt lgkmcnt(12)
    v_mfma_f32_16x16x32_bf16 v[140:143], v[156:159], v[88:91], v[140:143]
    ds_read_b64_tr_b16 v[104:105], v14 offset:512
    ds_read_b64_tr_b16 v[106:107], v14 offset:576
    v_mfma_f32_16x16x32_bf16 v[144:147], v[156:159], v[92:95], v[144:147]
    v_mfma_f32_16x16x32_bf16 v[148:151], v[156:159], v[112:115], v[148:151]
    s_waitcnt lgkmcnt(12)
    v_mfma_f32_16x16x32_bf16 v[140:143], v[84:87], v[124:127], v[140:143]
    ds_read2_b32 v[68:69], v16 offset0:16 offset1:17
    ds_read2_b32 v[70:71], v16 offset0:18 offset1:19
    v_mfma_f32_16x16x32_bf16 v[144:147], v[84:87], v[164:167], v[144:147]
    v_mfma_f32_16x16x32_bf16 v[148:151], v[84:87], v[64:67], v[148:151]
    s_waitcnt lgkmcnt(10)
    v_mfma_f32_16x16x32_bf16 v[140:143], v[108:111], v[96:99], v[140:143]
    ds_read_b64_tr_b16 v[116:117], v13 offset:2560
    ds_read_b64_tr_b16 v[118:119], v13 offset:2592
    ds_read_b64_tr_b16 v[120:121], v13 offset:2816
    ds_read_b64_tr_b16 v[122:123], v13 offset:2848
    s_waitcnt lgkmcnt(12)
    v_mfma_f32_16x16x32_bf16 v[144:147], v[100:103], v[88:91], v[144:147]
    ds_read2_b32 v[72:73], v16 offset0:0 offset1:1
    ds_read2_b32 v[74:75], v16 offset0:2 offset1:3
    v_mfma_f32_16x16x32_bf16 v[148:151], v[100:103], v[92:95], v[148:151]
    s_waitcnt lgkmcnt(12)
    v_mfma_f32_16x16x32_bf16 v[136:139], v[108:111], v[76:79], v[136:139]
    ds_read_b64_tr_b16 v[152:153], v14 offset:1024
    ds_read_b64_tr_b16 v[154:155], v14 offset:1088
    s_waitcnt lgkmcnt(12)
    v_mfma_f32_16x16x32_bf16 v[144:147], v[80:83], v[124:127], v[144:147]
    ds_read_b64_tr_b16 v[156:157], v14 offset:1536
    ds_read_b64_tr_b16 v[158:159], v14 offset:1600
    v_mfma_f32_16x16x32_bf16 v[148:151], v[80:83], v[164:167], v[148:151]
    s_waitcnt lgkmcnt(12)
    v_mfma_f32_16x16x32_bf16 v[140:143], v[104:107], v[76:79], v[140:143]
    ds_read_b128 v[112:115], v25 offset:3968
    s_waitcnt lgkmcnt(11)
    v_mfma_f32_16x16x32_bf16 v[144:147], v[108:111], v[68:71], v[144:147]
    ds_read_b64 v[84:85], v24 offset:3968
    ds_read_b64 v[86:87], v24 offset:3976
    s_waitcnt lgkmcnt(11)
    v_mfma_f32_16x16x32_bf16 v[148:151], v[116:119], v[88:91], v[148:151]
    ds_read_b128 v[64:67], v25 offset:3456
    ds_read_b64 v[100:101], v24 offset:3456
    ds_read_b64 v[102:103], v24 offset:3464
    s_waitcnt lgkmcnt(12)
    v_mfma_f32_16x16x32_bf16 v[148:151], v[120:123], v[124:127], v[148:151]
    ds_read_b128 v[92:95], v25 offset:2944
    v_mfma_f32_16x16x32_bf16 v[144:147], v[104:107], v[96:99], v[144:147]
    s_waitcnt lgkmcnt(11)
    v_mfma_f32_16x16x32_bf16 v[148:151], v[108:111], v[72:75], v[148:151]
    ds_read_b64 v[80:81], v24 offset:2944
    ds_read_b64 v[82:83], v24 offset:2952
    v_mfma_f32_16x16x32_bf16 v[148:151], v[104:107], v[68:71], v[148:151]
    s_waitcnt lgkmcnt(11)
    v_mfma_f32_16x16x32_bf16 v[144:147], v[152:155], v[76:79], v[144:147]
    ds_read_b128 v[164:167], v25 offset:2432
    ds_read_b128 v[116:119], v25 offset:1920
    v_mfma_f32_16x16x32_bf16 v[148:151], v[152:155], v[96:99], v[148:151]
    s_waitcnt lgkmcnt(11)
    v_mfma_f32_16x16x32_bf16 v[148:151], v[156:159], v[76:79], v[148:151]
    ds_read_b128 v[88:91], v25 offset:1408
    ds_read_b128 v[120:123], v25 offset:896
    s_waitcnt lgkmcnt(10)
    v_mfma_f32_16x16x32_bf16 v[60:63], v[112:115], v[84:87], v[60:63]
    ds_read_b128 v[124:127], v25 offset:384
    ds_read_b128 v[108:111], v25 offset:4032
    ds_read_b64 v[72:73], v24 offset:4032
    ds_read_b64 v[74:75], v24 offset:4040
    s_waitcnt lgkmcnt(13)
    v_mfma_f32_16x16x32_bf16 v[56:59], v[64:67], v[84:87], v[56:59]
    s_waitcnt lgkmcnt(11)
    v_mfma_f32_16x16x32_bf16 v[60:63], v[64:67], v[100:103], v[60:63]
    ds_read_b128 v[104:107], v25 offset:3520
    ds_read_b64 v[68:69], v24 offset:3520
    ds_read_b64 v[70:71], v24 offset:3528
    ds_write_b128 v4, v[128:131] offset:20688
    ds_write_b128 v4, v[132:135] offset:21712
    ds_write_b128 v4, v[136:139] offset:22736
    ds_write_b128 v4, v[140:143] offset:23760
    ds_write_b128 v4, v[144:147] offset:24784
    ds_write_b128 v4, v[148:151] offset:25808
    s_waitcnt lgkmcnt(15)
    v_mfma_f32_16x16x32_bf16 v[52:55], v[92:95], v[84:87], v[52:55]
    v_mfma_f32_16x16x32_bf16 v[56:59], v[92:95], v[100:103], v[56:59]
    v_mfma_f32_16x16x32_bf16 v[60:63], v[92:95], v[80:83], v[60:63]
    v_mfma_f32_16x16x32_bf16 v[48:51], v[164:167], v[84:87], v[48:51]
    v_mfma_f32_16x16x32_bf16 v[52:55], v[164:167], v[100:103], v[52:55]
    v_mfma_f32_16x16x32_bf16 v[56:59], v[164:167], v[80:83], v[56:59]
    v_mfma_f32_16x16x32_bf16 v[44:47], v[116:119], v[84:87], v[44:47]
    v_mfma_f32_16x16x32_bf16 v[48:51], v[116:119], v[100:103], v[48:51]
    ds_read_b128 v[128:131], v29 offset:20688
    ds_read_b128 v[132:135], v29 offset:21712
    ds_read_b128 v[136:139], v29 offset:22736
    ds_read_b128 v[140:143], v29 offset:23760
    ds_read_b128 v[144:147], v29 offset:24784
    ds_read_b128 v[148:151], v29 offset:25808
    v_mfma_f32_16x16x32_bf16 v[52:55], v[116:119], v[80:83], v[52:55]
    s_waitcnt lgkmcnt(15)
    v_mfma_f32_16x16x32_bf16 v[40:43], v[88:91], v[84:87], v[40:43]
    v_mfma_f32_16x16x32_bf16 v[44:47], v[88:91], v[100:103], v[44:47]
    v_mfma_f32_16x16x32_bf16 v[48:51], v[88:91], v[80:83], v[48:51]
    v_mfma_f32_16x16x32_bf16 v[36:39], v[120:123], v[84:87], v[36:39]
    v_mfma_f32_16x16x32_bf16 v[40:43], v[120:123], v[100:103], v[40:43]
    v_mfma_f32_16x16x32_bf16 v[44:47], v[120:123], v[80:83], v[44:47]
    v_mfma_f32_16x16x32_bf16 v[32:35], v[124:127], v[84:87], v[32:35]
    v_mfma_f32_16x16x32_bf16 v[36:39], v[124:127], v[100:103], v[36:39]
    v_mfma_f32_16x16x32_bf16 v[40:43], v[124:127], v[80:83], v[40:43]
    v_mfma_f32_16x16x32_bf16 v[60:63], v[108:111], v[72:75], v[60:63]
    s_waitcnt lgkmcnt(14)
    v_mfma_f32_16x16x32_bf16 v[56:59], v[104:107], v[72:75], v[56:59]
    s_waitcnt lgkmcnt(12)
    v_mfma_f32_16x16x32_bf16 v[60:63], v[104:107], v[68:71], v[60:63]
    ds_read_b128 v[152:155], v25 offset:3008
    s_waitcnt lgkmcnt(0)
    v_mfma_f32_16x16x32_bf16 v[52:55], v[152:155], v[72:75], v[52:55]
    ds_read_b64 v[96:97], v24 offset:3008
    ds_read_b64 v[98:99], v24 offset:3016
    ds_read_b128 v[156:159], v25 offset:2496
    ds_read_b128 v[76:79], v25 offset:1984
    ds_read_b128 v[112:115], v25 offset:1472
    ds_read_b128 v[64:67], v25 offset:960
    ds_read_b128 v[92:95], v25 offset:448
    v_mfma_f32_16x16x32_bf16 v[56:59], v[152:155], v[68:71], v[56:59]
    s_waitcnt lgkmcnt(5)
    v_mfma_f32_16x16x32_bf16 v[60:63], v[152:155], v[96:99], v[60:63]
    s_waitcnt lgkmcnt(4)
    v_mfma_f32_16x16x32_bf16 v[48:51], v[156:159], v[72:75], v[48:51]
    v_mfma_f32_16x16x32_bf16 v[52:55], v[156:159], v[68:71], v[52:55]
    v_mfma_f32_16x16x32_bf16 v[56:59], v[156:159], v[96:99], v[56:59]
    s_waitcnt lgkmcnt(3)
    v_mfma_f32_16x16x32_bf16 v[44:47], v[76:79], v[72:75], v[44:47]
    v_mfma_f32_16x16x32_bf16 v[48:51], v[76:79], v[68:71], v[48:51]
    v_mfma_f32_16x16x32_bf16 v[52:55], v[76:79], v[96:99], v[52:55]
    s_waitcnt lgkmcnt(2)
    v_mfma_f32_16x16x32_bf16 v[40:43], v[112:115], v[72:75], v[40:43]
    v_mfma_f32_16x16x32_bf16 v[44:47], v[112:115], v[68:71], v[44:47]
    v_mfma_f32_16x16x32_bf16 v[48:51], v[112:115], v[96:99], v[48:51]
    s_waitcnt lgkmcnt(1)
    v_mfma_f32_16x16x32_bf16 v[36:39], v[64:67], v[72:75], v[36:39]
    v_mfma_f32_16x16x32_bf16 v[40:43], v[64:67], v[68:71], v[40:43]
    v_mfma_f32_16x16x32_bf16 v[44:47], v[64:67], v[96:99], v[44:47]
    s_waitcnt lgkmcnt(0)
    v_mfma_f32_16x16x32_bf16 v[32:35], v[92:95], v[72:75], v[32:35]
    v_mfma_f32_16x16x32_bf16 v[36:39], v[92:95], v[68:71], v[36:39]
    v_mfma_f32_16x16x32_bf16 v[40:43], v[92:95], v[96:99], v[40:43]
    s_waitcnt lgkmcnt(0)
    v_add_f32 v60, v60, v148
    v_add_f32 v61, v61, v149
    v_add_f32 v62, v62, v150
    v_add_f32 v63, v63, v151
    v_add_f32 v56, v56, v144
    v_add_f32 v57, v57, v145
    v_add_f32 v58, v58, v146
    v_add_f32 v59, v59, v147
    v_add_f32 v52, v52, v140
    v_add_f32 v53, v53, v141
    v_add_f32 v54, v54, v142
    v_add_f32 v55, v55, v143
    v_add_f32 v48, v48, v136
    v_add_f32 v49, v49, v137
    v_add_f32 v50, v50, v138
    v_add_f32 v51, v51, v139
    v_add_f32 v44, v44, v132
    v_add_f32 v45, v45, v133
    v_add_f32 v46, v46, v134
    v_add_f32 v47, v47, v135
    v_add_f32 v40, v40, v128
    v_add_f32 v41, v41, v129
    v_add_f32 v42, v42, v130
    v_add_f32 v43, v43, v131
    v_cvt_pk_bf16_f32 v64, v32, v33
    v_cvt_pk_bf16_f32 v65, v34, v35
    v_cvt_pk_bf16_f32 v66, v36, v37
    v_cvt_pk_bf16_f32 v67, v38, v39
    v_or_b32 v64, 1, v64
    v_or_b32 v66, 1, v66
    buffer_store_dwordx4 v[64:67], v3, s[44:47], s15 offen offset:0 sc1
    v_cvt_pk_bf16_f32 v68, v40, v41
    v_cvt_pk_bf16_f32 v69, v42, v43
    v_cvt_pk_bf16_f32 v70, v44, v45
    v_cvt_pk_bf16_f32 v71, v46, v47
    v_or_b32 v68, 1, v68
    v_or_b32 v70, 1, v70
    buffer_store_dwordx4 v[68:71], v3, s[44:47], s15 offen offset:1024 sc1
    v_cvt_pk_bf16_f32 v72, v48, v49
    v_cvt_pk_bf16_f32 v73, v50, v51
    v_cvt_pk_bf16_f32 v74, v52, v53
    v_cvt_pk_bf16_f32 v75, v54, v55
    v_or_b32 v72, 1, v72
    v_or_b32 v74, 1, v74
    buffer_store_dwordx4 v[72:75], v3, s[44:47], s15 offen offset:2048 sc1
    v_cvt_pk_bf16_f32 v76, v56, v57
    v_cvt_pk_bf16_f32 v77, v58, v59
    v_cvt_pk_bf16_f32 v78, v60, v61
    v_cvt_pk_bf16_f32 v79, v62, v63
    v_or_b32 v76, 1, v76
    v_or_b32 v78, 1, v78
    buffer_store_dwordx4 v[76:79], v3, s[44:47], s15 offen offset:3072 sc1
    s_waitcnt vmcnt(0)
    v_mov_b32 v8, 34860
    v_mov_b32 v9, 1
    s_waitcnt lgkmcnt(0)
    s_mov_b64 exec, 1
    ds_add_u32 v8, v9
    s_mov_b64 exec, -1
    s_endpgm
.exit:
    s_endpgm
.section .rodata,"a"
.p2align 6
.amdhsa_kernel concat_heads__ssm_conv_s4d__spectral_gfnet__prompt_kernel
  .amdhsa_next_free_vgpr 168
  .amdhsa_next_free_sgpr 102
  .amdhsa_accum_offset 168
  .amdhsa_group_segment_fixed_size 0
  .amdhsa_kernarg_size 104
  .amdhsa_user_sgpr_count 2
  .amdhsa_user_sgpr_kernarg_segment_ptr 1
  .amdhsa_system_sgpr_workgroup_id_x 1
.end_amdhsa_kernel
```
